```python
import torch

def _softmax(x, axis=-1):
    return torch.softmax(x, dim=axis)
def _gelu(x):
    return torch.nn.functional.gelu(x, approximate="tanh")
def _silu(x):
    return torch.nn.functional.silu(x)
def _sigmoid(x):
    return torch.sigmoid(x)
def _layernorm(x, axis=-1, eps=1e-5):
    m = x.mean(dim=axis, keepdim=True)
    v = x.var(dim=axis, keepdim=True, unbiased=False)
    return (x - m) / torch.sqrt(v + eps)
def _scatter_add(tgt, idx, src, axis=0):
    return tgt.clone().index_add_(axis, idx, src)
def _segment_sum(src, seg, n):
    out = torch.zeros((n,) + src.shape[1:], dtype=src.dtype)
    return out.index_add_(0, seg, src)
def _pad(x, pw):
    flat = tuple(v for pair in reversed(pw) for v in pair)
    return torch.nn.functional.pad(x, flat)

kernel_name = 'standalone__cheap_equivariant_egnn__graph'

def setup_inputs():

    _w = (lambda a: (lambda t: t.to(torch.bfloat16) if t.is_floating_point() else t)(torch.as_tensor(a)))
    N, deg, D, De = 25000, 32, 64, max(0, 1)
    E = N * deg
    return {
        "h": _w((lambda *s: torch.randn(*s, dtype=torch.bfloat16) * 0.2)(N, D)),
        "pos": _w((lambda *s: torch.randn(*s, dtype=torch.bfloat16) * 0.8)(N, 3)),
        "e_attr": _w((lambda *s: torch.randn(*s, dtype=torch.bfloat16) * 0.8)(E, De)),
        "src": _w((lambda lo, hi, *s: torch.randint(lo, hi, s))(0, N, E).to(torch.int64)),
        "dst": _w((lambda lo, hi, *s: torch.randint(lo, hi, s))(0, N, E).to(torch.int64)),
        "w_e": _w(0.1 * (lambda *s: torch.randn(*s, dtype=torch.bfloat16) * 0.8)(2 * D + 1 + De, D)),
        "w_x": _w(0.1 * (lambda *s: torch.randn(*s, dtype=torch.bfloat16) * 0.2)(D, 1)),
        "w_h": _w(0.1 * (lambda *s: torch.randn(*s, dtype=torch.bfloat16) * 0.2)(2 * D, D)),
    }

def reference(h, pos, e_attr, src, dst, w_e, w_x, w_h):
    N, D = h.shape[0], h.shape[1]
    diff = pos[dst] - pos[src]
    dist2 = torch.sum(diff * diff, axis=-1, keepdims=True)
    e_in = torch.concatenate([h[dst], h[src], dist2, e_attr], axis=-1)
    m_ij = _silu(e_in @ w_e)
    coord_scale = m_ij @ w_x
    pos_new = pos + _segment_sum(diff * coord_scale, dst, N)
    m_i = _segment_sum(m_ij, dst, N)
    h_new = h + _silu(torch.concatenate([h, m_i], axis=-1) @ w_h)
    return h_new, pos_new
```

```asm
; @launch grid=(256,1,1) block=(512,1,1) lds=160128
.amdgcn_target "amdgcn-amd-amdhsa--gfx950"
.text
    .globl standalone__cheap_equivariant_egnn__graph_kernel
    .p2align 8
    .type standalone__cheap_equivariant_egnn__graph_kernel,@function
standalone__cheap_equivariant_egnn__graph_kernel:
    s_cmpk_ge_u32 s2, 256
    s_cbranch_scc1 K_end
    s_load_dwordx16 s[4:19], s[0:1], 0
    s_getpc_b64 s[26:27]
    v_lshrrev_b32 v247, 6, v0
    v_and_b32 v1, 63, v0
    v_mad_u32_u24 v162, v247, 12, v1
    v_lshlrev_b32 v162, 7, v162
    s_bfm_b64 exec, 12, 0
    global_load_dword v163, v162, s[26:27]
    s_mov_b64 exec, -1
    s_load_dwordx4 s[20:23], s[0:1], 64
    s_load_dwordx2 s[24:25], s[0:1], 80
    s_mul_i32 s89, s2, 782
    v_add_u32 v245, s89, v0
    v_lshlrev_b32 v2, 4, v245
    s_waitcnt lgkmcnt(0)
    global_load_dwordx4 v[106:109], v2, s[12:13] sc1 nt
    v_add_u32 v246, 0x200, v245
    s_mov_b32 s101, 200000
    v_cmp_gt_u32 s[82:83], s101, v246
    v_cmp_gt_u32 vcc, 270, v0
    v_lshlrev_b32 v3, 4, v246
    v_readfirstlane_b32 s3, v247
    s_and_b64 s[82:83], s[82:83], vcc
    s_mov_b32 s28, s12
    s_and_b32 s29, s13, 0xffff
    s_mov_b32 s30, 3200000
    s_mov_b32 s31, 0x00020000
    s_mov_b64 exec, s[82:83]
    buffer_load_dwordx4 v[116:119], v3, s[28:31], 0 offen sc1 nt
    s_mov_b64 exec, -1
    v_mov_b32 v210, 0
    v_cmp_gt_u32 s[80:81], s101, v245
    s_mov_b32 s101, s2
    s_and_b32 s84, s2, 7
    s_lshl_b32 s84, s84, 5
    s_lshr_b32 s89, s2, 3
    s_add_u32 s84, s84, s89
    s_mul_i32 s85, s84, 98
    s_lshr_b32 s86, s3, 1
    s_and_b32 s87, s3, 1
    v_lshlrev_b32 v4, 3, v245
    v_lshlrev_b32 v5, 3, v246
    v_lshrrev_b32 v249, 3, v1
    v_and_b32 v250, 7, v1
    v_mov_b32 v211, 0
    v_mov_b32 v212, 0
    v_mov_b32 v213, 0
    v_lshlrev_b32 v215, 4, v0
    s_cmp_lg_u32 s3, 7
    s_cbranch_scc1 K_nh1
    ds_write_b128 v215, v[210:213] offset:17920
K_nh1:
    s_mov_b32 s40, s24
    s_and_b32 s41, s25, 0xffff
    s_mov_b32 s42, 12582912
    s_mov_b32 s43, 0x00020000
    s_lshl_b32 s89, s101, 3
    s_add_u32 s89, s89, s3
    s_cmp_eq_u32 s89, 5
    s_cselect_b64 s[26:27], 1, 0
    s_mov_b32 s91, 7405568
    s_mov_b64 exec, s[26:27]
    buffer_load_dwordx2 v[186:187], v210, s[40:43], s91 offen sc1
    s_mov_b64 exec, -1
    s_mov_b32 s44, s4
    s_and_b32 s45, s5, 0xffff
    s_or_b32 s45, s45, 8388608
    s_mov_b32 s46, 25000
    s_mov_b32 s47, 0x00020000
    s_mov_b32 s64, s14
    s_and_b32 s65, s15, 0xffff
    s_mov_b32 s66, 16640
    s_mov_b32 s67, 0x00020000
    s_lshl_b32 s12, s3, 11
    s_lshl_b32 s13, s3, 10
    s_mov_b32 s14, 8192
    s_lshl_b32 s89, s3, 4
    s_add_u32 s89, s89, s85
    v_lshrrev_b32 v219, 4, v1
    v_xor_b32 v219, v250, v219
    v_lshlrev_b32 v203, 4, v219
    v_add_u32 v202, s89, v249
    v_xor_b32 v205, 64, v203
    v_add_u32 v204, 8, v202
    v_mov_b32 v207, v203
    s_add_u32 s89, s85, 98
    v_cmp_gt_u32 vcc, s89, v202
    v_cmp_gt_u32 s[0:1], s89, v204
    v_mov_b32 v219, 0x100000
    v_cndmask_b32 v202, v219, v202, vcc
    v_cndmask_b32 v204, v219, v204, s[0:1]
    s_add_u32 m0, s12, 127360
    s_nop 0
    buffer_load_dwordx4 v[202:203], s[44:47], 0 idxen offen sc1 nt lds
    s_add_u32 m0, s12, 128384
    s_nop 0
    buffer_load_dwordx4 v[204:205], s[44:47], 0 idxen offen sc1 nt lds
    s_add_u32 m0, s13, 58240
    s_nop 0
    buffer_load_dwordx4 v215, s[64:67], s14 offen lds
    s_mov_b32 s32, s10
    s_and_b32 s33, s11, 0xffff
    s_mov_b32 s34, 3200000
    s_mov_b32 s35, 0x00020000
    s_mov_b32 s36, s8
    s_and_b32 s37, s9, 0xffff
    s_mov_b32 s38, 1600000
    s_mov_b32 s39, 0x00020000
    s_mov_b32 s72, s6
    s_and_b32 s73, s7, 0xffff
    s_mov_b32 s74, 150000
    s_mov_b32 s75, 0x00020000
    s_mov_b32 s60, s22
    s_and_b32 s61, s23, 0xffff
    s_mov_b32 s62, 256
    s_mov_b32 s63, 0x00020000
    v_mov_b32 v209, v205
    v_and_b32 v220, 31, v1
    v_lshrrev_b32 v221, 5, v1
    v_bfe_u32 v222, v1, 1, 3
    v_bfe_u32 v223, v1, 2, 2
    v_bfe_u32 v225, v1, 4, 1
    v_and_b32 v214, 3, v1
    v_subrev_u32 v199, 0x180, v0
    v_add_u32 v198, s85, v199
    v_mul_u32_u24 v200, 6, v198
    v_lshlrev_b32 v201, 1, v1
    v_cmp_gt_u32 vcc, 152, v0
    ds_write_b128 v215, v[210:213] offset:31232
    ds_write_b128 v215, v[210:213] offset:39424
    s_mov_b64 exec, vcc
    ds_write_b128 v215, v[210:213] offset:47616
    s_mov_b64 exec, -1
    s_mov_b32 s68, s18
    s_and_b32 s69, s19, 0xffff
    s_mov_b32 s70, 16384
    s_mov_b32 s71, 0x00020000
    s_mov_b32 s76, s16
    s_and_b32 s77, s17, 0xffff
    s_mov_b32 s78, 128
    s_mov_b32 s79, 0x00020000
    s_add_u32 s48, s24, 6946816
    s_addc_u32 s49, s25, 0
    s_and_b32 s49, s49, 0xffff
    s_or_b32 s49, s49, 1048576
    s_mov_b32 s50, 25216
    s_mov_b32 s51, 0x00020000
    s_mov_b32 s52, s20
    s_and_b32 s53, s21, 0xffff
    s_mov_b32 s54, 3200000
    s_mov_b32 s55, 0x00020000
    s_add_u32 s56, s20, 3200000
    s_addc_u32 s57, s21, 0
    s_and_b32 s57, s57, 0xffff
    s_mov_b32 s58, 150000
    s_mov_b32 s59, 0x00020000
    s_mov_b32 s4, 42800
    s_mov_b32 s5, -98
    s_mov_b32 s6, 0xffff0000
    s_mov_b32 s7, 3216550459
    s_mul_i32 s8, s101, 15744
    s_add_u32 s9, s8, 8192
    v_mov_b32 v217, 1
    v_lshlrev_b32 v218, 4, v1
    v_lshl_or_b32 v224, v225, 2, v214
    v_lshl_or_b32 v245, v221, 3, v223
    v_lshlrev_b32 v245, 7, v245
    v_and_b32 v246, 1, v214
    v_lshrrev_b32 v247, 1, v214
    v_lshlrev_b32 v246, 5, v246
    v_lshl_or_b32 v246, v225, 4, v246
    v_lshl_or_b32 v246, v247, 3, v246
    s_lshl_b32 s89, s87, 6
    s_add_u32 s89, s89, 50048
    v_add3_u32 v248, v245, v246, s89
    v_lshl_add_u32 v246, v221, 10, v248
    s_lshl_b32 s89, s87, 12
    s_xor_b32 s90, s89, 4096
    v_add_u32 v247, s90, v246
    v_add_u32 v246, s89, v246
    s_lshl_b32 s89, s86, 12
    s_add_u32 s90, s89, 127360
    v_lshl_add_u32 v183, v220, 7, s90
    s_lshl_b32 s90, s87, 2
    v_lshlrev_b32 v182, 1, v221
    v_xor_b32 v182, s90, v182
    v_xor_b32 v182, v182, v222
    v_xor_b32 v178, 0, v182
    v_lshl_add_u32 v178, v178, 4, v183
    v_xor_b32 v179, 1, v182
    v_lshl_add_u32 v179, v179, 4, v183
    v_xor_b32 v180, 4, v182
    v_lshl_add_u32 v180, v180, 4, v183
    v_xor_b32 v181, 5, v182
    v_lshl_add_u32 v181, v181, 4, v183
    s_add_u32 s90, s12, 143744
    v_and_b32 v245, 3, v222
    v_lshlrev_b32 v253, 1, v221
    v_xor_b32 v253, v253, v245
    v_lshlrev_b32 v253, 4, v253
    v_lshl_add_u32 v253, v220, 6, v253
    v_add_u32 v253, s90, v253
    v_add_u32 v7, s90, v218
    s_lshl_b32 s89, s86, 5
    v_lshrrev_b32 v245, 2, v1
    v_add_u32 v245, s89, v245
    v_cmp_gt_u32 vcc, 98, v245
    s_movk_i32 s90, 82
    v_cmp_gt_u32 s[18:19], s90, v245
    v_add_u32 v245, s85, v245
    v_xor_b32 v252, v249, v1
    v_and_b32 v252, 3, v252
    v_lshlrev_b32 v245, 7, v245
    v_lshl_add_u32 v245, v252, 4, v245
    s_lshl_b32 s90, s87, 6
    v_add_u32 v245, s90, v245
    v_mov_b32 v219, 0x1000000
    v_cndmask_b32 v252, v219, v245, vcc
    v_cndmask_b32 v254, v219, v245, s[18:19]
    v_cmp_gt_u32 vcc, 468, v0
    v_lshlrev_b32 v251, 5, v1
    s_lshl_b32 s15, s101, 11
    s_add_u32 s15, s15, 6422528
    v_cndmask_b32 v219, v219, v215, vcc
    v_lshlrev_b32 v6, 1, v220
    s_waitcnt lgkmcnt(0)
    s_barrier
    s_waitcnt vmcnt(3)
    buffer_load_dwordx4 v[110:113], v2, s[32:35], 0 offen sc1 nt
    buffer_load_dwordx2 v[114:115], v4, s[36:39], 0 offen sc1 nt
    s_mov_b64 exec, s[82:83]
    buffer_load_dwordx4 v[120:123], v3, s[32:35], 0 offen sc1 nt
    buffer_load_dwordx2 v[124:125], v5, s[36:39], 0 offen sc1 nt
    s_cmp_ge_u32 s3, 6
    s_cselect_b64 exec, -1, 0
    buffer_load_ushort v194, v200, s[72:75], 0 offen offset:0
    buffer_load_ushort v195, v200, s[72:75], 0 offen offset:2
    buffer_load_ushort v196, v200, s[72:75], 0 offen offset:4
    s_cmp_eq_u32 s3, 5
    s_cselect_b64 exec, -1, 0
    s_mov_b32 s89, 16384
    buffer_load_ushort v194, v201, s[64:67], s89 offen offset:0
    buffer_load_ushort v195, v201, s[64:67], s89 offen offset:128
    s_mov_b64 exec, -1
    s_mov_b64 exec, s[26:27]
    s_cbranch_execz K_notok
    v_add_u32 v186, 1, v186
    v_add_u32 v187, 1, v187
    v_mov_b32 v190, v186
    v_lshl_or_b32 v191, v187, 24, 1
    buffer_store_dwordx2 v[190:191], v210, s[60:63], 0 offen sc1
    buffer_store_dwordx2 v[186:187], v210, s[40:43], s91 offen sc1
K_notok:
    s_mov_b64 exec, s[80:81]
    v_mul_u32_u24 v142, s4, v106
    v_mul_u32_u24 v143, s4, v107
    v_mul_u32_u24 v144, s4, v108
    v_mul_u32_u24 v145, s4, v109
    v_lshrrev_b32 v142, 22, v142
    v_lshrrev_b32 v143, 22, v143
    v_lshrrev_b32 v144, 22, v144
    v_lshrrev_b32 v145, 22, v145
    v_mad_i32_i24 v127, v142, s5, v106
    v_mad_i32_i24 v129, v143, s5, v107
    v_mad_i32_i24 v131, v144, s5, v108
    v_mad_i32_i24 v133, v145, s5, v109
    v_lshlrev_b32 v142, 2, v142
    v_lshlrev_b32 v143, 2, v143
    v_lshlrev_b32 v144, 2, v144
    v_lshlrev_b32 v145, 2, v145
    ds_add_rtn_u32 v150, v142, v217 offset:25088
    ds_add_rtn_u32 v151, v143, v217 offset:25088
    ds_add_rtn_u32 v152, v144, v217 offset:25088
    ds_add_rtn_u32 v153, v145, v217 offset:25088
    s_mov_b64 exec, s[82:83]
    s_cbranch_execz K_h1
    v_mul_u32_u24 v146, s4, v116
    v_mul_u32_u24 v147, s4, v117
    v_mul_u32_u24 v148, s4, v118
    v_mul_u32_u24 v149, s4, v119
    v_lshrrev_b32 v146, 22, v146
    v_lshrrev_b32 v147, 22, v147
    v_lshrrev_b32 v148, 22, v148
    v_lshrrev_b32 v149, 22, v149
    v_mad_i32_i24 v135, v146, s5, v116
    v_mad_i32_i24 v137, v147, s5, v117
    v_mad_i32_i24 v139, v148, s5, v118
    v_mad_i32_i24 v141, v149, s5, v119
    v_lshlrev_b32 v146, 2, v146
    v_lshlrev_b32 v147, 2, v147
    v_lshlrev_b32 v148, 2, v148
    v_lshlrev_b32 v149, 2, v149
    ds_add_rtn_u32 v154, v146, v217 offset:25088
    ds_add_rtn_u32 v155, v147, v217 offset:25088
    ds_add_rtn_u32 v156, v148, v217 offset:25088
    ds_add_rtn_u32 v157, v149, v217 offset:25088
K_h1:
    s_mov_b64 exec, -1
    s_waitcnt lgkmcnt(0)
    s_barrier
    ds_read_b128 v[158:161], v218 offset:25088
    s_waitcnt lgkmcnt(0)
    v_add_u32 v162, v158, v159
    v_add_u32 v163, v162, v160
    v_add_u32 v164, v163, v161
    v_mov_b32 v165, v164
    s_nop 1
    v_add_u32_dpp v165, v165, v165 row_shr:1 row_mask:0xf bank_mask:0xf bound_ctrl:1
    s_nop 1
    v_add_u32_dpp v165, v165, v165 row_shr:2 row_mask:0xf bank_mask:0xf bound_ctrl:1
    s_nop 1
    v_add_u32_dpp v165, v165, v165 row_shr:4 row_mask:0xf bank_mask:0xf bound_ctrl:1
    s_nop 1
    v_add_u32_dpp v165, v165, v165 row_shr:8 row_mask:0xf bank_mask:0xf bound_ctrl:1
    s_nop 1
    v_add_u32_dpp v165, v165, v165 row_bcast:15 row_mask:0xa bank_mask:0xf
    s_nop 1
    v_add_u32_dpp v165, v165, v165 row_bcast:31 row_mask:0xc bank_mask:0xf
    v_sub_u32 v166, v165, v164
    v_add_u32 v167, v166, v158
    v_add_u32 v168, v166, v162
    v_add_u32 v169, v166, v163
    ds_write_b128 v218, v[166:169] offset:26112
    s_mov_b64 exec, s[80:81]
    ds_read_b32 v142, v142 offset:26112
    ds_read_b32 v143, v143 offset:26112
    ds_read_b32 v144, v144 offset:26112
    ds_read_b32 v145, v145 offset:26112
    s_mov_b64 exec, s[82:83]
    ds_read_b32 v146, v146 offset:26112
    ds_read_b32 v147, v147 offset:26112
    ds_read_b32 v148, v148 offset:26112
    ds_read_b32 v149, v149 offset:26112
    s_mov_b64 exec, -1
    s_waitcnt vmcnt(0)
    v_lshl_or_b32 v126, v114, 16, v110
    v_and_or_b32 v128, v114, s6, v111
    v_lshl_or_b32 v130, v115, 16, v112
    v_and_or_b32 v132, v115, s6, v113
    v_lshl_or_b32 v134, v124, 16, v120
    v_and_or_b32 v136, v124, s6, v121
    v_lshl_or_b32 v138, v125, 16, v122
    v_and_or_b32 v140, v125, s6, v123
    s_waitcnt lgkmcnt(0)
    v_add_u32 v142, v142, v150
    v_add_u32 v143, v143, v151
    v_add_u32 v144, v144, v152
    v_add_u32 v145, v145, v153
    v_add_u32 v146, v146, v154
    v_add_u32 v147, v147, v155
    v_add_u32 v148, v148, v156
    v_add_u32 v149, v149, v157
    s_mov_b64 exec, s[80:81]
    ds_write_b8 v142, v127 offset:12544
    ds_write_b8 v143, v129 offset:12544
    ds_write_b8 v144, v131 offset:12544
    ds_write_b8 v145, v133 offset:12544
    s_mov_b64 exec, s[82:83]
    ds_write_b8 v146, v135 offset:12544
    ds_write_b8 v147, v137 offset:12544
    ds_write_b8 v148, v139 offset:12544
    ds_write_b8 v149, v141 offset:12544
    s_mov_b64 exec, -1
    v_xor_b32 v245, 16, v253
    v_lshlrev_b32 v142, 2, v142
    v_lshlrev_b32 v143, 2, v143
    v_lshlrev_b32 v144, 2, v144
    v_lshlrev_b32 v145, 2, v145
    v_lshlrev_b32 v146, 2, v146
    v_lshlrev_b32 v147, 2, v147
    v_lshlrev_b32 v148, 2, v148
    v_lshlrev_b32 v149, 2, v149
    s_mov_b64 exec, s[80:81]
    ds_write_b32 v142, v126 offset:0
    ds_write_b32 v143, v128 offset:0
    ds_write_b32 v144, v130 offset:0
    ds_write_b32 v145, v132 offset:0
    s_mov_b64 exec, s[82:83]
    ds_write_b32 v146, v134 offset:0
    ds_write_b32 v147, v136 offset:0
    ds_write_b32 v148, v138 offset:0
    ds_write_b32 v149, v140 offset:0
    s_mov_b64 exec, -1
    s_cmp_lt_u32 s3, 6
    s_cbranch_scc1 K_nopf
    s_mov_b32 s89, 25000
    v_cmp_gt_u32 vcc, 98, v199
    v_cmp_gt_u32 s[16:17], s89, v198
    v_lshlrev_b32 v194, 16, v194
    v_lshlrev_b32 v195, 16, v195
    v_lshlrev_b32 v196, 16, v196
    v_mov_b32 v197, 0
    v_lshlrev_b32 v199, 4, v199
    ds_write_b128 v199, v[194:197] offset:29184
    s_and_b64 s[16:17], s[16:17], vcc
K_nopf:
    s_add_u32 m0, s13, 50048
    s_nop 0
    buffer_load_dwordx4 v215, s[64:67], 0 offen lds
    buffer_load_ushort v242, v6, s[76:79], 0 offen
    buffer_load_ushort v243, v6, s[76:79], 0 offen offset:64
    s_cmp_eq_u32 s3, 4
    s_cselect_b64 exec, -1, 0
    buffer_load_dwordx2 v[186:187], v210, s[60:63], 0 offen sc1
    s_mov_b64 exec, -1
    s_add_u32 m0, s12, 66432
    s_nop 0
    buffer_load_dwordx4 v218, s[68:71], s12 offen lds
    buffer_load_dwordx4 v218, s[68:71], s12 offen offset:1024 lds
    s_waitcnt lgkmcnt(0)
    s_barrier
    ds_read_b128 v[106:109], v215 offset:0
    ds_read_b128 v[110:113], v215 offset:8192
    ds_read_b128 v[66:69], v178
    ds_read_b128 v[70:73], v179
    ds_read_b128 v[90:93], v180
    ds_read_b128 v[94:97], v181
    ds_read_b64_tr_b16 v[10:11], v246 offset:8192
    ds_read_b64_tr_b16 v[12:13], v246 offset:8704
    ds_read_b64_tr_b16 v[14:15], v246 offset:9216
    ds_read_b64_tr_b16 v[16:17], v246 offset:9728
    ds_read_b64_tr_b16 v[18:19], v247 offset:8192
    ds_read_b64_tr_b16 v[20:21], v247 offset:8704
    ds_read_b64_tr_b16 v[22:23], v247 offset:9216
    ds_read_b64_tr_b16 v[24:25], v247 offset:9728
    s_waitcnt lgkmcnt(13)
    buffer_store_dwordx4 v[106:109], v215, s[40:43], s8 offen sc1
    s_waitcnt lgkmcnt(12)
    buffer_store_dwordx4 v[110:113], v219, s[40:43], s9 offen sc1
    s_cmp_ge_u32 s3, 6
    s_cselect_b64 exec, s[16:17], 0
    buffer_store_dwordx4 v[194:197], v198, s[48:51], 0 idxen sc1
    s_mov_b64 exec, -1
    s_waitcnt lgkmcnt(0)
    v_mfma_f32_32x32x16_bf16 v[74:89], v[10:13], v[66:69], 0
    v_mfma_f32_32x32x16_bf16 v[74:89], v[14:17], v[70:73], v[74:89]
    v_mfma_f32_32x32x16_bf16 v[74:89], v[18:21], v[90:93], v[74:89]
    v_mfma_f32_32x32x16_bf16 v[74:89], v[22:25], v[94:97], v[74:89]
    s_waitcnt vmcnt(3)
    s_nop 6
    s_cmp_lg_u32 s3, 4
    s_cbranch_scc1 K_row_done
    s_mov_b32 s89, 0
K_tk:
    v_readfirstlane_b32 s90, v187
    s_add_u32 s89, s89, 1
    s_cmp_gt_u32 s89, 0x40000
    s_cbranch_scc1 K_tkok
    s_bitcmp1_b32 s90, 0
    s_cbranch_scc1 K_tkok
    buffer_load_dwordx2 v[186:187], v210, s[60:63], 0 offen sc1
    s_waitcnt vmcnt(0)
    s_branch K_tk
K_tkok:
    v_and_b32 v187, 0xff000000, v187
    v_mov_b32 v188, 32432
    ds_write_b64 v188, v[186:187]
    v_lshl_or_b32 v26, v158, 12, v166
    v_mov_b32 v27, v186
    v_or_b32 v26, v26, v187
    v_lshl_or_b32 v28, v159, 12, v167
    v_mov_b32 v29, v186
    v_or_b32 v28, v28, v187
    v_lshl_or_b32 v30, v160, 12, v168
    v_mov_b32 v31, v186
    v_or_b32 v30, v30, v187
    v_lshl_or_b32 v32, v161, 12, v169
    v_mov_b32 v33, v186
    v_or_b32 v32, v32, v187
K_row_done:
    s_nop 2
    v_mul_f32 v74, s7, v74
    v_mul_f32 v75, s7, v75
    v_mul_f32 v76, s7, v76
    v_mul_f32 v77, s7, v77
    v_mul_f32 v78, s7, v78
    v_mul_f32 v79, s7, v79
    v_mul_f32 v80, s7, v80
    v_mul_f32 v81, s7, v81
    v_mul_f32 v82, s7, v82
    v_mul_f32 v83, s7, v83
    v_mul_f32 v84, s7, v84
    v_mul_f32 v85, s7, v85
    v_mul_f32 v86, s7, v86
    v_mul_f32 v87, s7, v87
    v_mul_f32 v88, s7, v88
    v_mul_f32 v89, s7, v89
    v_cvt_pk_bf16_f32 v178, v74, v75
    v_cvt_pk_bf16_f32 v179, v76, v77
    v_cvt_pk_bf16_f32 v180, v78, v79
    v_cvt_pk_bf16_f32 v181, v80, v81
    v_cvt_pk_bf16_f32 v182, v82, v83
    v_cvt_pk_bf16_f32 v183, v84, v85
    v_cvt_pk_bf16_f32 v184, v86, v87
    v_cvt_pk_bf16_f32 v185, v88, v89
    ds_write_b128 v253, v[178:181]
    ds_write_b128 v245, v[182:185]
    ds_read_b128 v[74:77], v7
    ds_read_b128 v[78:81], v7 offset:1024
    s_add_u32 s72, s24, 8388608
    s_addc_u32 s73, s25, 0
    s_and_b32 s73, s73, 0xffff
    s_mov_b32 s74, 3200000
    s_mov_b32 s75, 0x00020000
    s_waitcnt lgkmcnt(1)
    buffer_store_dwordx4 v[74:77], v252, s[72:75], 0 offen sc1
    s_waitcnt lgkmcnt(0)
    buffer_store_dwordx4 v[78:81], v254, s[72:75], 0 offen offset:2048 sc1
    s_waitcnt vmcnt(3)
    s_barrier
    s_cmp_eq_u32 s3, 4
    s_cselect_b64 exec, -1, 0
    buffer_store_dwordx4 v[26:29], v251, s[40:43], s15 offen sc1
    buffer_store_dwordx4 v[30:33], v251, s[40:43], s15 offen offset:16 sc1
    s_mov_b64 exec, -1
    ds_read_b64 v[186:187], v210 offset:32432
    ds_read_b64_tr_b16 v[10:11], v246 offset:0
    ds_read_b64_tr_b16 v[12:13], v246 offset:512
    ds_read_b64_tr_b16 v[14:15], v246 offset:1024
    ds_read_b64_tr_b16 v[16:17], v246 offset:1536
    ds_read_b64_tr_b16 v[18:19], v247 offset:0
    ds_read_b64_tr_b16 v[20:21], v247 offset:512
    ds_read_b64_tr_b16 v[22:23], v247 offset:1024
    ds_read_b64_tr_b16 v[24:25], v247 offset:1536
    s_waitcnt lgkmcnt(0)
    v_mfma_f32_32x32x16_bf16 v[74:89], v[10:13], v[66:69], 0
    v_mfma_f32_32x32x16_bf16 v[74:89], v[14:17], v[70:73], v[74:89]
    v_mfma_f32_32x32x16_bf16 v[74:89], v[18:21], v[90:93], v[74:89]
    v_mfma_f32_32x32x16_bf16 v[74:89], v[22:25], v[94:97], v[74:89]
    v_readfirstlane_b32 s60, v186
    v_readfirstlane_b32 s61, v187
    s_add_u32 s44, s24, 8385536
    s_addc_u32 s45, s25, 0
    s_and_b32 s45, s45, 0xffff
    s_or_b32 s45, s45, 8388608
    s_mov_b32 s46, 25000
    s_mov_b32 s47, 0x00020000
    s_lshl_b32 s89, s86, 5
    v_add_u32 v216, s89, v220
    v_mul_u32_u24 v216, 144, v216
    s_lshl_b32 s89, s87, 6
    s_add_u32 s89, s89, 108848
    v_lshl_add_u32 v216, v221, 5, v216
    v_add_u32 v216, s89, v216
    ds_read_b64_tr_b16 v[138:139], v246 offset:16384
    ds_read_b64_tr_b16 v[140:141], v246 offset:16896
    ds_read_b64_tr_b16 v[142:143], v246 offset:17408
    ds_read_b64_tr_b16 v[144:145], v246 offset:17920
    ds_read_b64_tr_b16 v[146:147], v247 offset:16384
    ds_read_b64_tr_b16 v[148:149], v247 offset:16896
    ds_read_b64_tr_b16 v[150:151], v247 offset:17408
    ds_read_b64_tr_b16 v[152:153], v247 offset:17920
    ds_read_b64_tr_b16 v[50:51], v248 offset:24576
    ds_read_b64_tr_b16 v[52:53], v248 offset:25088
    ds_read_b64_tr_b16 v[54:55], v248 offset:26624
    ds_read_b64_tr_b16 v[56:57], v248 offset:27136
    ds_read_b64_tr_b16 v[58:59], v248 offset:28672
    ds_read_b64_tr_b16 v[60:61], v248 offset:29184
    ds_read_b64_tr_b16 v[62:63], v248 offset:30720
    ds_read_b64_tr_b16 v[64:65], v248 offset:31232
    v_mul_f32 v74, s7, v74
    v_mul_f32 v75, s7, v75
    v_mul_f32 v76, s7, v76
    v_mul_f32 v77, s7, v77
    v_mul_f32 v78, s7, v78
    v_mul_f32 v79, s7, v79
    v_mul_f32 v80, s7, v80
    v_mul_f32 v81, s7, v81
    v_mul_f32 v82, s7, v82
    v_mul_f32 v83, s7, v83
    v_mul_f32 v84, s7, v84
    v_mul_f32 v85, s7, v85
    v_mul_f32 v86, s7, v86
    v_mul_f32 v87, s7, v87
    v_mul_f32 v88, s7, v88
    v_mul_f32 v89, s7, v89
    v_cvt_pk_bf16_f32 v178, v74, v75
    v_cvt_pk_bf16_f32 v179, v76, v77
    v_cvt_pk_bf16_f32 v180, v78, v79
    v_cvt_pk_bf16_f32 v181, v80, v81
    v_cvt_pk_bf16_f32 v182, v82, v83
    v_cvt_pk_bf16_f32 v183, v84, v85
    v_cvt_pk_bf16_f32 v184, v86, v87
    v_cvt_pk_bf16_f32 v185, v88, v89
    s_waitcnt lgkmcnt(8)
    v_mfma_f32_32x32x16_bf16 v[34:49], v[138:141], v[66:69], 0
    v_mfma_f32_32x32x16_bf16 v[34:49], v[142:145], v[70:73], v[34:49]
    v_mfma_f32_32x32x16_bf16 v[34:49], v[146:149], v[90:93], v[34:49]
    v_mfma_f32_32x32x16_bf16 v[34:49], v[150:153], v[94:97], v[34:49]
    ds_write_b128 v216, v[178:181]
    ds_write_b128 v216, v[182:185] offset:16
    v_mfma_f32_32x32x16_bf16 v[74:89], v[210:213], v[210:213], 0
    v_mfma_f32_32x32x16_bf16 v[90:105], v[210:213], v[210:213], 0
    s_cmp_eq_u32 s3, 5
    s_cbranch_scc1 K_side5
    s_cmp_lg_u32 s3, 4
    s_cbranch_scc1 K_side_done
    v_mul_u32_u24 v194, 18, v1
    v_mov_b32 v195, 0x3f80
    s_mov_b64 exec, 0xff
    ds_write_b16 v194, v195 offset:31232
    s_mov_b64 exec, -1
    s_branch K_side_done
K_side5:
    v_lshlrev_b32 v194, 16, v194
    v_lshlrev_b32 v195, 16, v195
    v_mul_f32 v194, s7, v194
    v_mul_f32 v195, s7, v195
    v_cvt_pk_bf16_f32 v196, v194, v195
    v_lshlrev_b32 v197, 16, v196
    v_sub_f32 v194, v194, v197
    v_and_b32 v197, s6, v196
    v_sub_f32 v195, v195, v197
    v_cvt_pk_bf16_f32 v197, v194, v195
    ds_write_b16 v201, v196 offset:32448
    ds_write_b16_d16_hi v201, v196 offset:32592
    ds_write_b16 v201, v197 offset:32736
    ds_write_b16_d16_hi v201, v197 offset:32880
K_side_done:
    v_lshlrev_b32 v2, 3, v221
    v_sub_u32 v2, v220, v2
    v_subrev_u32 v6, 16, v2
    v_min_u32 v2, 8, v2
    v_min_u32 v6, 8, v6
    v_lshlrev_b32 v2, 4, v2
    v_lshlrev_b32 v6, 4, v6
    s_mov_b32 s98, 0
    s_mov_b32 s99, 32
    v_add_u32 v248, 50048, v215
    v_cmp_gt_u32 vcc, 91, v0
    s_lshl_b32 s14, s101, 7
    s_add_u32 s14, s14, 7471104
    v_lshrrev_b32 v176, 2, v1
    v_lshlrev_b32 v176, 11, v176
    s_lshl_b32 s89, s3, 16
    s_lshl_b32 s90, s84, 3
    s_add_u32 s89, s89, s90
    s_add_u32 s16, s89, 6422528
    s_add_u32 s17, s16, 32768
    s_waitcnt vmcnt(2) lgkmcnt(0)
    s_barrier
    s_cmp_eq_u32 s3, 3
    s_cselect_b64 exec, 1, 0
    buffer_store_dwordx2 v[186:187], v210, s[40:43], s14 offen sc1
    s_mov_b64 exec, -1
    ds_read_b128 v[2:5], v2 offset:31232
    ds_read_b128 v[6:9], v6 offset:31232
    ds_write_b128 v248, v[210:213] offset:0
    ds_write_b128 v248, v[210:213] offset:8192
    ds_write_b128 v248, v[210:213] offset:16384
    ds_write_b128 v248, v[210:213] offset:24576
    ds_write_b128 v248, v[210:213] offset:32768
    ds_write_b128 v248, v[210:213] offset:40960
    ds_write_b128 v248, v[210:213] offset:49152
    s_mov_b64 exec, vcc
    ds_write_b128 v248, v[210:213] offset:57344
    s_mov_b64 exec, -1
    s_lshl_b32 s88, s3, 12
    s_add_u32 s88, s88, 127360
    v_lshlrev_b32 v229, 3, v1
    v_lshlrev_b32 v230, 3, v249
    v_lshl_add_u32 v146, v220, 7, s88
    v_xor_b32 v147, v221, v222
    v_lshl_add_u32 v231, v147, 4, v146
    v_xor_b32 v232, 2, v147
    v_lshl_add_u32 v232, v232, 4, v146
    v_xor_b32 v233, 4, v147
    v_lshl_add_u32 v233, v233, 4, v146
    v_xor_b32 v234, 6, v147
    v_lshl_add_u32 v234, v234, 4, v146
    s_lshl_b32 s89, s3, 11
    s_add_u32 s89, s89, 33664
    v_lshl_add_u32 v237, v220, 6, s89
    v_lshl_or_b32 v237, v222, 3, v237
    v_mov_b32 v226, v237
    v_lshl_or_b32 v146, v221, 2, v223
    v_lshrrev_b32 v147, 1, v146
    v_xor_b32 v147, v147, v224
    v_lshl_add_u32 v146, v146, 6, s89
    v_lshl_add_u32 v235, v147, 3, v146
    v_xor_b32 v147, 4, v147
    v_lshl_add_u32 v236, v147, 3, v146
    v_add_u32 v236, 0x200, v236
    v_mul_u32_u24 v239, 144, v223
    v_lshl_add_u32 v239, v224, 3, v239
    s_mov_b32 s89, -76400
    v_mad_i32_i24 v239, v221, s89, v239
    v_add_u32 v239, 108848, v239
    v_mov_b32 v238, v239
    v_mul_u32_u24 v240, 528, v221
    v_lshl_add_u32 v240, v220, 3, v240
    v_add_u32 v240, 50048, v240
    v_lshl_or_b32 v241, v223, 1, v221
    v_lshlrev_b32 v241, 5, v241
    v_add_u32 v241, 105488, v241
    v_lshlrev_b32 v242, 16, v242
    v_lshlrev_b32 v243, 16, v243
    v_add_u32 v203, 0xc00, v203
    v_add_u32 v205, 0x800, v205
    v_add_u32 v207, 0x400, v207
    s_mov_b32 s94, -1
    v_mov_b32 v29, 0x1000000
    s_mov_b32 s95, 0
    s_mov_b32 s96, 0x11111111
    s_mov_b32 s97, 0x11111111
    s_mov_b32 s92, 3216550459
    s_mov_b32 s93, 3216550459
    v_mul_f32 v242, 3207688728, v242
    v_mul_f32 v243, 3207688728, v243
    v_mov_b32 v186, 0
    v_mov_b32 v187, 0
    v_mov_b32 v188, 0
    v_mov_b32 v189, 0
    v_mov_b32 v190, 0
    v_mov_b32 v191, 0
    v_mov_b32 v192, 0
    v_mov_b32 v193, 0
    v_mov_b32 v194, 0
    v_mov_b32 v195, 0
    v_mov_b32 v196, 0
    v_mov_b32 v197, 0
    v_mov_b32 v198, 0
    v_mov_b32 v199, 0
    v_mov_b32 v200, 0
    v_mov_b32 v201, 0
    s_mov_b32 s89, 15744
    v_lshrrev_b32 v174, 2, v1
    v_and_b32 v175, 3, v1
    v_mul_u32_u24 v174, s89, v174
    v_mad_u32_u24 v175, v175, 6, s98
    s_mul_i32 s36, s3, 503808
    s_add_u32 s37, s36, 251904
    v_add_u32 v173, v174, v175
    v_add_u32 v173, 12544, v173
    v_lshl_add_u32 v174, v175, 2, v174
    s_add_u32 s38, s98, 24
    s_waitcnt lgkmcnt(0)
    buffer_load_dwordx2 v[162:163], v176, s[40:43], s16 offen sc1
    buffer_load_dwordx2 v[164:165], v176, s[40:43], s17 offen sc1
    s_mov_b32 s89, 0
K_poll:
    s_waitcnt vmcnt(0)
    v_xor_b32 v138, s61, v162
    v_xor_b32 v139, s60, v163
    v_xor_b32 v140, s61, v164
    v_xor_b32 v141, s60, v165
    v_lshrrev_b32 v138, 24, v138
    v_lshrrev_b32 v140, 24, v140
    v_or_b32 v138, v138, v139
    v_or_b32 v140, v140, v141
    v_cmp_ne_u32 s[4:5], 0, v138
    v_cmp_ne_u32 s[6:7], 0, v140
    s_add_u32 s89, s89, 1
    s_cmp_gt_u32 s89, 0x40000
    s_cbranch_scc1 K_pollx
    s_or_b64 s[12:13], s[4:5], s[6:7]
    s_cbranch_scc1 K_repoll
K_pollx:
    v_bfe_u32 v132, v162, 12, 12
    v_and_b32 v176, 0xfff, v162
    v_sub_u32 v134, v132, v175
    v_add_u32 v130, v176, v173
    v_cmp_lt_i32 s[4:5], 0, v134
    v_lshl_add_u32 v128, v176, 2, v174
    v_cmp_lt_i32 s[12:13], 4, v134
    s_mov_b64 exec, s[4:5]
    buffer_load_dwordx2 v[122:123], v130, s[40:43], s36 offen sc1
    s_mov_b64 exec, -1
    v_bfe_u32 v133, v164, 12, 12
    v_and_b32 v176, 0xfff, v164
    v_sub_u32 v135, v133, v175
    v_add_u32 v131, v176, v173
    v_cmp_lt_i32 s[16:17], 0, v135
    v_lshl_add_u32 v129, v176, 2, v174
    v_cmp_lt_i32 s[24:25], 4, v135
    s_mov_b64 exec, s[16:17]
    buffer_load_dwordx2 v[124:125], v131, s[40:43], s37 offen sc1
    s_mov_b64 exec, -1
    v_max_u32 v244, v132, v133
    s_mov_b64 exec, s[4:5]
    buffer_load_dwordx4 v[106:109], v128, s[40:43], s36 offen sc1
    s_mov_b64 exec, s[12:13]
    buffer_load_dwordx2 v[110:111], v128, s[40:43], s36 offen offset:16 sc1
    s_mov_b64 exec, s[16:17]
    buffer_load_dwordx4 v[112:115], v129, s[40:43], s37 offen sc1
    s_mov_b64 exec, s[24:25]
    buffer_load_dwordx2 v[116:117], v129, s[40:43], s37 offen offset:16 sc1
    s_mov_b64 exec, -1
    v_cmp_lt_u32 vcc, s38, v244
    s_mov_b32 s76, 0
    v_cmp_lt_i32 s[6:7], 1, v134
    v_cmp_lt_i32 s[8:9], 2, v134
    v_cmp_lt_i32 s[10:11], 3, v134
    v_cmp_lt_i32 s[14:15], 5, v134
    v_cmp_lt_i32 s[18:19], 1, v135
    v_cmp_lt_i32 s[20:21], 2, v135
    v_cmp_lt_i32 s[22:23], 3, v135
    v_cmp_lt_i32 s[26:27], 5, v135
    s_cbranch_vccnz K_ovla
K_ovlba:
K_hist:
    v_mov_b32 v176, 1
    v_and_b32 v245, 31, v1
    v_lshlrev_b32 v245, 7, v245
    s_lshl_b32 s62, s3, 12
    s_add_u32 s62, s62, 7471104
    s_waitcnt vmcnt(5)
    v_lshlrev_b32_sdwa v138, 2, v122 dst_sel:DWORD dst_unused:UNUSED_PAD src0_sel:DWORD src1_sel:BYTE_0
    v_lshlrev_b32_sdwa v139, 2, v122 dst_sel:DWORD dst_unused:UNUSED_PAD src0_sel:DWORD src1_sel:BYTE_1
    v_lshlrev_b32_sdwa v140, 2, v122 dst_sel:DWORD dst_unused:UNUSED_PAD src0_sel:DWORD src1_sel:BYTE_2
    v_lshlrev_b32_sdwa v141, 2, v122 dst_sel:DWORD dst_unused:UNUSED_PAD src0_sel:DWORD src1_sel:BYTE_3
    v_lshlrev_b32_sdwa v142, 2, v123 dst_sel:DWORD dst_unused:UNUSED_PAD src0_sel:DWORD src1_sel:BYTE_0
    v_lshlrev_b32_sdwa v143, 2, v123 dst_sel:DWORD dst_unused:UNUSED_PAD src0_sel:DWORD src1_sel:BYTE_1
    s_mov_b64 exec, s[4:5]
    ds_add_rtn_u32 v154, v138, v176 offset:31392
    s_mov_b64 exec, s[6:7]
    ds_add_rtn_u32 v155, v139, v176 offset:31392
    s_mov_b64 exec, s[8:9]
    ds_add_rtn_u32 v156, v140, v176 offset:31392
    s_mov_b64 exec, s[10:11]
    ds_add_rtn_u32 v157, v141, v176 offset:31392
    s_mov_b64 exec, s[12:13]
    ds_add_rtn_u32 v158, v142, v176 offset:31392
    s_mov_b64 exec, s[14:15]
    ds_add_rtn_u32 v159, v143, v176 offset:31392
    s_mov_b64 exec, -1
    s_waitcnt vmcnt(4)
    v_lshlrev_b32_sdwa v144, 2, v124 dst_sel:DWORD dst_unused:UNUSED_PAD src0_sel:DWORD src1_sel:BYTE_0
    v_lshlrev_b32_sdwa v145, 2, v124 dst_sel:DWORD dst_unused:UNUSED_PAD src0_sel:DWORD src1_sel:BYTE_1
    v_lshlrev_b32_sdwa v146, 2, v124 dst_sel:DWORD dst_unused:UNUSED_PAD src0_sel:DWORD src1_sel:BYTE_2
    v_lshlrev_b32_sdwa v147, 2, v124 dst_sel:DWORD dst_unused:UNUSED_PAD src0_sel:DWORD src1_sel:BYTE_3
    v_lshlrev_b32_sdwa v148, 2, v125 dst_sel:DWORD dst_unused:UNUSED_PAD src0_sel:DWORD src1_sel:BYTE_0
    v_lshlrev_b32_sdwa v149, 2, v125 dst_sel:DWORD dst_unused:UNUSED_PAD src0_sel:DWORD src1_sel:BYTE_1
    s_mov_b64 exec, s[16:17]
    ds_add_rtn_u32 v160, v144, v176 offset:31392
    s_mov_b64 exec, s[18:19]
    ds_add_rtn_u32 v161, v145, v176 offset:31392
    s_mov_b64 exec, s[20:21]
    ds_add_rtn_u32 v162, v146, v176 offset:31392
    s_mov_b64 exec, s[22:23]
    ds_add_rtn_u32 v163, v147, v176 offset:31392
    s_mov_b64 exec, s[24:25]
    ds_add_rtn_u32 v164, v148, v176 offset:31392
    s_mov_b64 exec, s[26:27]
    ds_add_rtn_u32 v165, v149, v176 offset:31392
    s_mov_b64 exec, -1
    s_cmp_lg_u32 s76, 0
    s_cbranch_scc1 K_ovh
K_ovhb:
    buffer_load_dwordx2 v[216:217], v245, s[40:43], s62 offen sc1
    s_waitcnt lgkmcnt(0)
    s_barrier
    ds_read_b64 v[170:171], v229 offset:31392
    s_add_u32 s89, s98, s99
    v_cmp_lt_u32 vcc, s89, v244
    s_waitcnt lgkmcnt(0)
    v_add_u32 v176, v170, v171
    v_mov_b32 v177, v176
    s_nop 1
    v_add_u32_dpp v177, v177, v177 row_shr:1 row_mask:0xf bank_mask:0xf bound_ctrl:1
    s_nop 1
    v_add_u32_dpp v177, v177, v177 row_shr:2 row_mask:0xf bank_mask:0xf bound_ctrl:1
    s_nop 1
    v_add_u32_dpp v177, v177, v177 row_shr:4 row_mask:0xf bank_mask:0xf bound_ctrl:1
    s_nop 1
    v_add_u32_dpp v177, v177, v177 row_shr:8 row_mask:0xf bank_mask:0xf bound_ctrl:1
    s_nop 1
    v_add_u32_dpp v177, v177, v177 row_bcast:15 row_mask:0xa bank_mask:0xf
    s_nop 1
    v_add_u32_dpp v177, v177, v177 row_bcast:31 row_mask:0xc bank_mask:0xf
    v_sub_u32 v172, v177, v176
    v_readlane_b32 s100, v177, 63
    v_add_u32 v173, v172, v170
    ds_write_b64 v229, v[172:173] offset:31904
    s_cmp_gt_u32 s100, 3584
    s_cbranch_scc1 K_retry
    s_mov_b64 exec, s[4:5]
    ds_read_b32 v138, v138 offset:31904
    s_mov_b64 exec, s[6:7]
    ds_read_b32 v139, v139 offset:31904
    s_mov_b64 exec, s[8:9]
    ds_read_b32 v140, v140 offset:31904
    s_mov_b64 exec, s[10:11]
    ds_read_b32 v141, v141 offset:31904
    s_mov_b64 exec, s[12:13]
    ds_read_b32 v142, v142 offset:31904
    s_mov_b64 exec, s[14:15]
    ds_read_b32 v143, v143 offset:31904
    s_mov_b64 exec, s[16:17]
    ds_read_b32 v144, v144 offset:31904
    s_mov_b64 exec, s[18:19]
    ds_read_b32 v145, v145 offset:31904
    s_mov_b64 exec, s[20:21]
    ds_read_b32 v146, v146 offset:31904
    s_mov_b64 exec, s[22:23]
    ds_read_b32 v147, v147 offset:31904
    s_mov_b64 exec, s[24:25]
    ds_read_b32 v148, v148 offset:31904
    s_mov_b64 exec, s[26:27]
    ds_read_b32 v149, v149 offset:31904
    s_mov_b64 exec, -1
    s_cbranch_vccnz K_setflag
K_flagset:
    s_add_u32 s90, s100, 31
    s_lshr_b32 s90, s90, 5
    s_lshr_b32 s89, s90, 3
    s_and_b32 s90, s90, 7
    s_mul_i32 s64, s3, s89
    s_min_u32 s91, s3, s90
    s_add_u32 s64, s64, s91
    s_add_u32 s66, s64, s89
    s_cmp_lt_u32 s3, s90
    s_addc_u32 s66, s66, 0
    s_lshl_b32 s64, s64, 5
    s_lshl_b32 s66, s66, 5
    s_min_u32 s66, s66, s100
    s_lshl_b32 s89, s100, 3
    v_add_u32 v176, s89, v229
    s_mov_b32 s63, 0
K_flg:
    s_waitcnt vmcnt(0)
    v_cmp_ne_u32 vcc, s60, v216
    v_cmp_ne_u32 s[0:1], s61, v217
    s_lshr_b32 s89, s101, 3
    s_lshl_b32 s90, s3, 5
    s_or_b64 vcc, vcc, s[0:1]
    s_cbranch_scc1 K_reflg
K_flgok:
    s_add_u32 s89, s89, s90
    s_and_b32 s90, s89, 7
    s_lshl_b32 s90, s90, 5
    s_lshr_b32 s89, s89, 3
    s_add_u32 s89, s89, s90
    s_mul_i32 s89, s89, 98
    s_add_u32 s90, s89, 7
    s_and_b32 s90, s90, -8
    v_lshl_add_u32 v216, v1, 3, s90
    s_mov_b64 exec, 0x7ff
    buffer_load_dword v216, v216, s[48:51], 0 idxen sc1
    s_mov_b64 exec, -1
    s_waitcnt lgkmcnt(8)
    v_add_lshl_u32 v138, v138, v154, 3
    v_add_lshl_u32 v139, v139, v155, 3
    v_add_lshl_u32 v140, v140, v156, 3
    v_add_lshl_u32 v141, v141, v157, 3
    v_lshlrev_b32_sdwa v154, 4, v122 dst_sel:DWORD dst_unused:UNUSED_PAD src0_sel:DWORD src1_sel:BYTE_0
    v_lshlrev_b32_sdwa v155, 4, v122 dst_sel:DWORD dst_unused:UNUSED_PAD src0_sel:DWORD src1_sel:BYTE_1
    v_lshlrev_b32_sdwa v156, 4, v122 dst_sel:DWORD dst_unused:UNUSED_PAD src0_sel:DWORD src1_sel:BYTE_2
    v_lshlrev_b32_sdwa v157, 4, v122 dst_sel:DWORD dst_unused:UNUSED_PAD src0_sel:DWORD src1_sel:BYTE_3
    s_mov_b64 exec, s[4:5]
    ds_write2_b32 v138, v106, v154 offset0:0 offset1:1
    s_mov_b64 exec, s[6:7]
    ds_write2_b32 v139, v107, v155 offset0:0 offset1:1
    s_mov_b64 exec, s[8:9]
    ds_write2_b32 v140, v108, v156 offset0:0 offset1:1
    s_mov_b64 exec, s[10:11]
    ds_write2_b32 v141, v109, v157 offset0:0 offset1:1
    s_mov_b64 exec, -1
    s_waitcnt lgkmcnt(8)
    v_add_lshl_u32 v142, v142, v158, 3
    v_add_lshl_u32 v143, v143, v159, 3
    v_add_lshl_u32 v144, v144, v160, 3
    v_add_lshl_u32 v145, v145, v161, 3
    v_lshlrev_b32_sdwa v158, 4, v123 dst_sel:DWORD dst_unused:UNUSED_PAD src0_sel:DWORD src1_sel:BYTE_0
    v_lshlrev_b32_sdwa v159, 4, v123 dst_sel:DWORD dst_unused:UNUSED_PAD src0_sel:DWORD src1_sel:BYTE_1
    v_lshlrev_b32_sdwa v160, 4, v124 dst_sel:DWORD dst_unused:UNUSED_PAD src0_sel:DWORD src1_sel:BYTE_0
    v_lshlrev_b32_sdwa v161, 4, v124 dst_sel:DWORD dst_unused:UNUSED_PAD src0_sel:DWORD src1_sel:BYTE_1
    s_mov_b64 exec, s[12:13]
    ds_write2_b32 v142, v110, v158 offset0:0 offset1:1
    s_mov_b64 exec, s[14:15]
    ds_write2_b32 v143, v111, v159 offset0:0 offset1:1
    s_mov_b64 exec, s[16:17]
    ds_write2_b32 v144, v112, v160 offset0:0 offset1:1
    s_mov_b64 exec, s[18:19]
    ds_write2_b32 v145, v113, v161 offset0:0 offset1:1
    s_mov_b64 exec, -1
    s_waitcnt lgkmcnt(8)
    v_add_lshl_u32 v146, v146, v162, 3
    v_add_lshl_u32 v147, v147, v163, 3
    v_add_lshl_u32 v148, v148, v164, 3
    v_add_lshl_u32 v149, v149, v165, 3
    v_lshlrev_b32_sdwa v162, 4, v124 dst_sel:DWORD dst_unused:UNUSED_PAD src0_sel:DWORD src1_sel:BYTE_2
    v_lshlrev_b32_sdwa v163, 4, v124 dst_sel:DWORD dst_unused:UNUSED_PAD src0_sel:DWORD src1_sel:BYTE_3
    v_lshlrev_b32_sdwa v164, 4, v125 dst_sel:DWORD dst_unused:UNUSED_PAD src0_sel:DWORD src1_sel:BYTE_0
    v_lshlrev_b32_sdwa v165, 4, v125 dst_sel:DWORD dst_unused:UNUSED_PAD src0_sel:DWORD src1_sel:BYTE_1
    s_mov_b64 exec, s[20:21]
    ds_write2_b32 v146, v114, v162 offset0:0 offset1:1
    s_mov_b64 exec, s[22:23]
    ds_write2_b32 v147, v115, v163 offset0:0 offset1:1
    s_mov_b64 exec, s[24:25]
    ds_write2_b32 v148, v116, v164 offset0:0 offset1:1
    s_mov_b64 exec, s[26:27]
    ds_write2_b32 v149, v117, v165 offset0:0 offset1:1
    s_mov_b64 exec, -1
    s_cmp_lg_u32 s76, 0
    s_cbranch_scc1 K_ovs
K_ovsb:
    s_cmp_lg_u32 s3, 7
    s_cbranch_scc1 K_nopad
    ds_write_b64 v176, v[210:211] offset:0
K_nopad:
    s_lshl_b32 s67, s64, 3
    s_mov_b32 s68, 0
    s_mov_b32 s70, 0
    v_add_u32 v227, s67, v229
    v_add_u32 v228, s67, v230
    v_mov_b32 v154, 0
    v_mov_b32 v155, 0
    v_mov_b32 v156, 0
    v_mov_b32 v157, 0
    v_mov_b32 v158, 0
    v_mov_b32 v159, 0
    v_mov_b32 v160, 0
    v_mov_b32 v161, 0
    s_waitcnt lgkmcnt(0)
    s_barrier
    s_cmp_ge_u32 s64, s66
    s_cbranch_scc1 K_skip
    s_mov_b32 m0, s88
    ds_read_b64 v[214:215], v227 offset:0
    ds_read_u16 v219, v227 offset:0
    ds_read_u16 v202, v228 offset:0
    ds_read_u16 v204, v228 offset:64
    ds_read_u16 v206, v228 offset:128
    ds_read_u16 v208, v228 offset:192
    s_sub_u32 s83, s66, s64
    s_min_u32 s76, s83, 64
    s_bfm_b64 s[80:81], s83, 0
    s_cmp_ge_u32 s83, 64
    s_cselect_b64 s[80:81], -1, s[80:81]
    s_mov_b32 s72, 0
    s_waitcnt lgkmcnt(0)
    s_waitcnt lgkmcnt(0)
    v_cmp_gt_u32 vcc, s68, v215
    buffer_load_dwordx3 v[216:218], v219, s[48:51], 0 idxen sc1
    ds_read_b128 v[220:223], v215 offset:29184
    buffer_load_dwordx4 v[202:203], s[44:47], 0 idxen offen offset:0 sc1 lds
    buffer_load_dwordx4 v[204:205], s[44:47], 0 idxen offen offset:1024 sc1 lds
    buffer_load_dwordx4 v[206:207], s[44:47], 0 idxen offen offset:2048 sc1 lds
    buffer_load_dwordx4 v[208:209], s[44:47], 0 idxen offen offset:3072 sc1 lds
    s_and_b64 s[78:79], vcc, s[80:81]
    s_bcnt1_i32_b64 s74, s[78:79]
    s_cmp_lg_u32 s74, s76
    s_cbranch_scc1 K_win_1a
K_win_1b:
    s_add_u32 s65, s64, s74
    s_mov_b32 s72, 0
    s_mul_i32 s89, s69, 9
    s_mov_b64 exec, s[94:95]
    v_add_u32 v238, s89, v239
    s_mov_b64 exec, -1
    ds_read_b64_tr_b16 v[178:179], v238 offset:0
    ds_read_b64_tr_b16 v[180:181], v238 offset:576
    ds_read_b64_tr_b16 v[182:183], v238 offset:64
    ds_read_b64_tr_b16 v[184:185], v238 offset:640
    ds_read_u16 v202, v228 offset:256
    ds_read_u16 v204, v228 offset:320
    ds_read_u16 v206, v228 offset:384
    ds_read_u16 v208, v228 offset:448
    s_cmp_lg_u32 s98, 0
    s_cbranch_scc1 K_noepi
    v_and_b32 v141, 31, v1
    v_lshrrev_b32 v142, 5, v1
    v_bfe_u32 v143, v1, 1, 3
    v_and_b32 v144, 3, v1
    s_lshl_b32 s89, s86, 5
    v_add_u32 v138, s89, v141
    v_mul_u32_u24 v26, 528, v138
    v_lshl_add_u32 v26, v142, 6, v26
    v_add_u32 v26, 50048, v26
    v_lshlrev_b32 v27, 2, v0
    v_lshlrev_b32 v28, 3, v0
    v_add_u32 v28, 105488, v28
    v_lshrrev_b32 v29, 2, v0
    v_cmp_gt_u32 vcc, 98, v29
    v_cmp_gt_u32 s[36:37], 3, v144
    v_add_u32 v29, s85, v29
    v_mul_u32_u24 v29, 6, v29
    v_lshl_add_u32 v29, v144, 1, v29
    s_and_b64 vcc, s[36:37], vcc
    v_mov_b32 v140, 0x1000000
    v_and_b32 v138, 3, v143
    v_cndmask_b32 v29, v140, v29, vcc
    v_lshlrev_b32 v139, 1, v142
    v_xor_b32 v139, v139, v138
    v_lshl_add_u32 v30, v141, 6, s88
    v_lshl_add_u32 v30, v139, 4, v30
    v_xor_b32 v31, 16, v30
    v_lshl_add_u32 v32, v1, 4, s88
    v_lshlrev_b32 v10, 16, v66
    v_and_b32 v11, 0xffff0000, v66
    v_lshlrev_b32 v12, 16, v67
    v_and_b32 v13, 0xffff0000, v67
    v_lshlrev_b32 v14, 16, v68
    v_and_b32 v15, 0xffff0000, v68
    v_lshlrev_b32 v16, 16, v69
    v_and_b32 v17, 0xffff0000, v69
    v_lshlrev_b32 v18, 16, v70
    v_and_b32 v19, 0xffff0000, v70
    v_lshlrev_b32 v20, 16, v71
    v_and_b32 v21, 0xffff0000, v71
    v_lshlrev_b32 v22, 16, v72
    v_and_b32 v23, 0xffff0000, v72
    v_lshlrev_b32 v24, 16, v73
    v_and_b32 v25, 0xffff0000, v73
K_noepi:
    s_lshl_b32 s67, s65, 3
    s_mov_b32 s64, s65
    s_mov_b32 s73, s72
    s_mov_b32 s71, s70
    s_mov_b32 s70, s69
    s_mov_b32 s75, s74
    s_sub_u32 s83, s66, s64
    s_min_u32 s76, s83, 64
    s_bfm_b64 s[80:81], s83, 0
    s_cmp_ge_u32 s83, 64
    s_cselect_b64 s[80:81], -1, s[80:81]
    s_mov_b32 s72, 0
    s_waitcnt vmcnt(4)
    s_waitcnt lgkmcnt(8)
    ds_write_b64 v226, v[210:211]
    v_subrev_u32 v245, s69, v215
    v_sub_f32 v246, v220, v216
    v_sub_f32 v247, v221, v217
    v_sub_f32 v248, v222, v218
    v_min_u32 v186, 0x80, v245
    v_mul_f32 v223, v246, v246
    v_lshrrev_b32 v245, 1, v186
    v_fmac_f32 v223, v247, v247
    v_cvt_pk_bf16_f32 v224, 1.0, v246
    v_fmac_f32 v223, v248, v248
    v_cvt_pk_bf16_f32 v225, v247, v248
    v_cvt_pk_bf16_f32 v190, v223, v214
    v_xor_b32 v226, v245, v237
    s_waitcnt vmcnt(0)
    ds_read_b128 v[162:165], v231
    ds_read_b128 v[166:169], v232
    ds_read_b128 v[170:173], v233
    ds_read_b128 v[174:177], v234
    s_mov_b32 s77, s79
    v_permlane32_swap_b32 v186, v190
    v_mov_b32 v187, v186
    v_mov_b32 v191, v190
    s_and_b64 exec, s[78:79], s[94:95]
    ds_write_b64 v226, v[224:225]
    s_mov_b64 exec, s[94:95]
    ds_read_b128 v[186:189], v186 offset:31232
    ds_read_b128 v[190:193], v190 offset:31232
    s_mov_b64 exec, -1
    s_waitcnt lgkmcnt(2)
    buffer_load_dwordx4 v[202:203], s[44:47], 0 idxen offen offset:0 sc1 lds
    buffer_load_dwordx4 v[204:205], s[44:47], 0 idxen offen offset:1024 sc1 lds
    buffer_load_dwordx4 v[206:207], s[44:47], 0 idxen offen offset:2048 sc1 lds
    buffer_load_dwordx4 v[208:209], s[44:47], 0 idxen offen offset:3072 sc1 lds
    v_mfma_f32_32x32x16_bf16 v[106:121], v[162:165], v[2:5], 0
    v_mfma_f32_32x32x16_bf16 v[106:121], v[166:169], v[6:9], v[106:121]
    s_waitcnt lgkmcnt(0)
    v_mfma_f32_32x32x16_bf16 v[106:121], v[186:189], v[178:181], v[106:121]
    s_nop 5
    s_setprio 3
    .p2align 4
K_loop:
    v_add_u32 v227, s67, v229
    v_add_u32 v228, s67, v230
    ds_read_b64 v[214:215], v227 offset:0
    ds_read_u16 v219, v227 offset:0
    v_mfma_f32_32x32x16_bf16 v[122:137], v[186:189], v[182:185], 0
    v_exp_f32 v138, v106
    v_exp_f32 v139, v107
    v_exp_f32 v140, v108
    v_exp_f32 v141, v109
    v_mfma_f32_32x32x16_bf16 v[90:105], v[194:197], v[154:157], v[90:105]
    v_exp_f32 v142, v110
    v_exp_f32 v143, v111
    v_exp_f32 v144, v112
    v_exp_f32 v145, v113
    v_mfma_f32_32x32x16_bf16 v[90:105], v[198:201], v[158:161], v[90:105]
    v_exp_f32 v146, v114
    v_exp_f32 v147, v115
    ds_read_b64_tr_b16 v[194:195], v235 offset:0
    ds_read_b64_tr_b16 v[196:197], v236 offset:0
    ds_read_b64_tr_b16 v[198:199], v235 offset:1024
    ds_read_b64_tr_b16 v[200:201], v236 offset:1024
    ds_write_b64 v226, v[210:211]
    s_mov_b32 exec_lo, 0
    s_mov_b32 exec_hi, s77
    ds_write_b64 v226, v[224:225]
    s_mov_b64 exec, -1
    v_exp_f32 v148, v116
    v_exp_f32 v149, v117
    v_exp_f32 v150, v118
    v_exp_f32 v151, v119
    v_exp_f32 v152, v120
    v_exp_f32 v153, v121
    s_waitcnt lgkmcnt(5)
    v_cmp_gt_u32 vcc, s68, v215
    buffer_load_dwordx3 v[216:218], v219, s[48:51], 0 idxen sc1
    ds_read_b128 v[220:223], v215 offset:29184
    v_pk_add_f32 v[138:139], v[138:139], 1.0 op_sel_hi:[1,0]
    s_and_b64 s[78:79], vcc, s[80:81]
    v_pk_add_f32 v[140:141], v[140:141], 1.0 op_sel_hi:[1,0]
    s_bcnt1_i32_b64 s74, s[78:79]
    v_pk_add_f32 v[142:143], v[142:143], 1.0 op_sel_hi:[1,0]
    s_cmp_lg_u32 s74, s76
    v_pk_add_f32 v[144:145], v[144:145], 1.0 op_sel_hi:[1,0]
    s_cbranch_scc1 K_win_2a
K_win_2b:
    v_pk_add_f32 v[146:147], v[146:147], 1.0 op_sel_hi:[1,0]
    s_add_u32 s65, s64, s74
    v_pk_add_f32 v[148:149], v[148:149], 1.0 op_sel_hi:[1,0]
    v_pk_add_f32 v[150:151], v[150:151], 1.0 op_sel_hi:[1,0]
    v_pk_add_f32 v[152:153], v[152:153], 1.0 op_sel_hi:[1,0]
    v_mfma_f32_32x32x16_bf16 v[122:137], v[170:173], v[2:5], v[122:137]
    v_rcp_f32 v138, v138
    v_rcp_f32 v139, v139
    v_rcp_f32 v140, v140
    v_rcp_f32 v141, v141
    v_mfma_f32_32x32x16_bf16 v[122:137], v[174:177], v[6:9], v[122:137]
    v_rcp_f32 v142, v142
    v_rcp_f32 v143, v143
    v_rcp_f32 v144, v144
    v_rcp_f32 v145, v145
    v_rcp_f32 v146, v146
    v_rcp_f32 v147, v147
    v_rcp_f32 v148, v148
    v_rcp_f32 v149, v149
    v_rcp_f32 v150, v150
    v_rcp_f32 v151, v151
    v_rcp_f32 v152, v152
    v_rcp_f32 v153, v153
    v_pk_mul_f32 v[138:139], v[106:107], v[138:139]
    s_cmp_le_u32 s83, 192
    v_pk_mul_f32 v[140:141], v[108:109], v[140:141]
    s_cbranch_scc1 K_prioa
K_prioba:
    v_pk_mul_f32 v[142:143], v[110:111], v[142:143]
    v_pk_mul_f32 v[144:145], v[112:113], v[144:145]
    v_pk_mul_f32 v[146:147], v[114:115], v[146:147]
    v_pk_mul_f32 v[148:149], v[116:117], v[148:149]
    v_pk_mul_f32 v[150:151], v[118:119], v[150:151]
    v_pk_mul_f32 v[152:153], v[120:121], v[152:153]
    v_cvt_pk_bf16_f32 v154, v138, v139
    v_cvt_pk_bf16_f32 v155, v140, v141
    v_cvt_pk_bf16_f32 v156, v142, v143
    v_cvt_pk_bf16_f32 v157, v144, v145
    v_cvt_pk_bf16_f32 v158, v146, v147
    v_cvt_pk_bf16_f32 v159, v148, v149
    v_cvt_pk_bf16_f32 v160, v150, v151
    s_cmp_lg_u32 s73, 0
    v_cvt_pk_bf16_f32 v161, v152, v153
    s_cbranch_scc1 K_flush
K_flushb:
    s_waitcnt vmcnt(1)
    ds_read_b128 v[162:165], v231
    ds_read_b128 v[166:169], v232
    ds_read_b128 v[170:173], v233
    ds_read_b128 v[174:177], v234
    ds_read_u16 v202, v228 offset:0
    ds_read_u16 v204, v228 offset:64
    ds_read_u16 v206, v228 offset:128
    ds_read_u16 v208, v228 offset:192
    v_mfma_f32_32x32x16_bf16 v[106:121], v[190:193], v[178:181], 0
    v_exp_f32 v138, v122
    v_exp_f32 v139, v123
    v_exp_f32 v140, v124
    v_exp_f32 v141, v125
    s_waitcnt lgkmcnt(10)
    v_mfma_f32_32x32x16_bf16 v[74:89], v[194:197], v[154:157], v[74:89]
    v_exp_f32 v142, v126
    v_exp_f32 v143, v127
    v_exp_f32 v144, v128
    v_exp_f32 v145, v129
    v_mfma_f32_32x32x16_bf16 v[74:89], v[198:201], v[158:161], v[74:89]
    v_exp_f32 v146, v130
    v_exp_f32 v147, v131
    v_exp_f32 v148, v132
    v_exp_f32 v149, v133
    v_exp_f32 v150, v134
    v_exp_f32 v151, v135
    v_exp_f32 v152, v136
    v_exp_f32 v153, v137
    s_waitcnt lgkmcnt(0)
    buffer_load_dwordx4 v[202:203], s[44:47], 0 idxen offen offset:0 sc1 lds
    buffer_load_dwordx4 v[204:205], s[44:47], 0 idxen offen offset:1024 sc1 lds
    buffer_load_dwordx4 v[206:207], s[44:47], 0 idxen offen offset:2048 sc1 lds
    buffer_load_dwordx4 v[208:209], s[44:47], 0 idxen offen offset:3072 sc1 lds
    v_pk_add_f32 v[138:139], v[138:139], 1.0 op_sel_hi:[1,0]
    v_pk_add_f32 v[140:141], v[140:141], 1.0 op_sel_hi:[1,0]
    v_pk_add_f32 v[142:143], v[142:143], 1.0 op_sel_hi:[1,0]
    v_pk_add_f32 v[144:145], v[144:145], 1.0 op_sel_hi:[1,0]
    v_pk_add_f32 v[146:147], v[146:147], 1.0 op_sel_hi:[1,0]
    v_pk_add_f32 v[148:149], v[148:149], 1.0 op_sel_hi:[1,0]
    v_pk_add_f32 v[150:151], v[150:151], 1.0 op_sel_hi:[1,0]
    v_pk_add_f32 v[152:153], v[152:153], 1.0 op_sel_hi:[1,0]
    v_mfma_f32_32x32x16_bf16 v[106:121], v[162:165], v[2:5], v[106:121]
    v_rcp_f32 v138, v138
    v_rcp_f32 v139, v139
    v_rcp_f32 v140, v140
    v_rcp_f32 v141, v141
    v_mfma_f32_32x32x16_bf16 v[106:121], v[166:169], v[6:9], v[106:121]
    v_rcp_f32 v142, v142
    v_rcp_f32 v143, v143
    v_rcp_f32 v144, v144
    v_rcp_f32 v145, v145
    v_rcp_f32 v146, v146
    v_rcp_f32 v147, v147
    v_rcp_f32 v148, v148
    v_rcp_f32 v149, v149
    v_rcp_f32 v150, v150
    v_rcp_f32 v151, v151
    v_rcp_f32 v152, v152
    v_rcp_f32 v153, v153
    v_pk_mul_f32 v[138:139], v[122:123], v[138:139]
    v_pk_mul_f32 v[140:141], v[124:125], v[140:141]
    v_pk_mul_f32 v[142:143], v[126:127], v[142:143]
    v_pk_mul_f32 v[144:145], v[128:129], v[144:145]
    v_pk_mul_f32 v[146:147], v[130:131], v[146:147]
    v_pk_mul_f32 v[148:149], v[132:133], v[148:149]
    v_pk_mul_f32 v[150:151], v[134:135], v[150:151]
    v_pk_mul_f32 v[152:153], v[136:137], v[152:153]
    v_cvt_pk_bf16_f32 v154, v138, v139
    s_cmp_gt_u32 s75, 32
    v_cvt_pk_bf16_f32 v155, v140, v141
    s_cselect_b32 s89, 1, s74
    v_cvt_pk_bf16_f32 v156, v142, v143
    s_cmp_eq_u32 s89, 0
    v_cvt_pk_bf16_f32 v157, v144, v145
    v_cvt_pk_bf16_f32 v158, v146, v147
    v_cvt_pk_bf16_f32 v159, v148, v149
    v_cvt_pk_bf16_f32 v160, v150, v151
    v_cvt_pk_bf16_f32 v161, v152, v153
    s_cbranch_scc1 K_drain
    v_mfma_f32_32x32x16_bf16 v[122:137], v[190:193], v[182:185], 0
    v_exp_f32 v138, v106
    v_exp_f32 v139, v107
    v_exp_f32 v140, v108
    v_exp_f32 v141, v109
    v_mfma_f32_32x32x16_bf16 v[90:105], v[194:197], v[154:157], v[90:105]
    v_exp_f32 v142, v110
    v_exp_f32 v143, v111
    v_exp_f32 v144, v112
    v_exp_f32 v145, v113
    v_mfma_f32_32x32x16_bf16 v[90:105], v[198:201], v[158:161], v[90:105]
    v_exp_f32 v146, v114
    v_exp_f32 v147, v115
    ds_read_b64_tr_b16 v[194:195], v235 offset:0
    ds_read_b64_tr_b16 v[196:197], v236 offset:0
    ds_read_b64_tr_b16 v[198:199], v235 offset:1024
    ds_read_b64_tr_b16 v[200:201], v236 offset:1024
    ds_write_b64 v226, v[210:211]
    v_exp_f32 v148, v116
    v_exp_f32 v149, v117
    s_waitcnt vmcnt(4)
    v_subrev_u32 v245, s69, v215
    v_sub_f32 v246, v220, v216
    v_sub_f32 v247, v221, v217
    v_sub_f32 v248, v222, v218
    v_min_u32 v186, 0x80, v245
    v_mul_f32 v223, v246, v246
    v_lshrrev_b32 v245, 1, v186
    v_fmac_f32 v223, v247, v247
    v_cvt_pk_bf16_f32 v224, 1.0, v246
    v_fmac_f32 v223, v248, v248
    v_cvt_pk_bf16_f32 v225, v247, v248
    v_cvt_pk_bf16_f32 v190, v223, v214
    v_xor_b32 v226, v245, v237
    s_mov_b32 s77, s79
    v_permlane32_swap_b32 v186, v190
    v_mov_b32 v187, v186
    v_mov_b32 v191, v190
    s_and_b64 exec, s[78:79], s[94:95]
    ds_write_b64 v226, v[224:225]
    s_mov_b64 exec, s[94:95]
    ds_read_b128 v[186:189], v186 offset:31232
    ds_read_b128 v[190:193], v190 offset:31232
    s_mov_b64 exec, -1
    v_exp_f32 v150, v118
    v_exp_f32 v151, v119
    v_exp_f32 v152, v120
    v_exp_f32 v153, v121
    v_pk_add_f32 v[138:139], v[138:139], 1.0 op_sel_hi:[1,0]
    s_cmp_lg_u32 s72, 0
    v_pk_add_f32 v[140:141], v[140:141], 1.0 op_sel_hi:[1,0]
    s_cbranch_scc1 K_aw
K_awb:
    v_pk_add_f32 v[142:143], v[142:143], 1.0 op_sel_hi:[1,0]
    v_pk_add_f32 v[144:145], v[144:145], 1.0 op_sel_hi:[1,0]
    v_pk_add_f32 v[146:147], v[146:147], 1.0 op_sel_hi:[1,0]
    v_pk_add_f32 v[148:149], v[148:149], 1.0 op_sel_hi:[1,0]
    v_pk_add_f32 v[150:151], v[150:151], 1.0 op_sel_hi:[1,0]
    v_pk_add_f32 v[152:153], v[152:153], 1.0 op_sel_hi:[1,0]
    v_mfma_f32_32x32x16_bf16 v[122:137], v[170:173], v[2:5], v[122:137]
    v_rcp_f32 v138, v138
    v_rcp_f32 v139, v139
    v_rcp_f32 v140, v140
    v_rcp_f32 v141, v141
    v_mfma_f32_32x32x16_bf16 v[122:137], v[174:177], v[6:9], v[122:137]
    v_rcp_f32 v142, v142
    v_rcp_f32 v143, v143
    v_rcp_f32 v144, v144
    v_rcp_f32 v145, v145
    v_rcp_f32 v146, v146
    v_rcp_f32 v147, v147
    v_rcp_f32 v148, v148
    v_rcp_f32 v149, v149
    v_rcp_f32 v150, v150
    v_rcp_f32 v151, v151
    v_rcp_f32 v152, v152
    v_rcp_f32 v153, v153
    v_pk_mul_f32 v[138:139], v[106:107], v[138:139]
    v_pk_mul_f32 v[140:141], v[108:109], v[140:141]
    v_pk_mul_f32 v[142:143], v[110:111], v[142:143]
    v_pk_mul_f32 v[144:145], v[112:113], v[144:145]
    v_pk_mul_f32 v[146:147], v[114:115], v[146:147]
    v_pk_mul_f32 v[148:149], v[116:117], v[148:149]
    v_pk_mul_f32 v[150:151], v[118:119], v[150:151]
    v_pk_mul_f32 v[152:153], v[120:121], v[152:153]
    v_cvt_pk_bf16_f32 v154, v138, v139
    v_cvt_pk_bf16_f32 v155, v140, v141
    v_cvt_pk_bf16_f32 v156, v142, v143
    v_cvt_pk_bf16_f32 v157, v144, v145
    v_cvt_pk_bf16_f32 v158, v146, v147
    v_cvt_pk_bf16_f32 v159, v148, v149
    v_cvt_pk_bf16_f32 v160, v150, v151
    v_cvt_pk_bf16_f32 v161, v152, v153
    s_waitcnt vmcnt(0)
    ds_read_b128 v[162:165], v231
    ds_read_b128 v[166:169], v232
    ds_read_b128 v[170:173], v233
    ds_read_b128 v[174:177], v234
    ds_read_u16 v202, v228 offset:256
    ds_read_u16 v204, v228 offset:320
    ds_read_u16 v206, v228 offset:384
    ds_read_u16 v208, v228 offset:448
    s_waitcnt lgkmcnt(8)
    v_mfma_f32_32x32x16_bf16 v[106:121], v[186:189], v[178:181], 0
    v_exp_f32 v138, v122
    v_exp_f32 v139, v123
    v_exp_f32 v140, v124
    v_exp_f32 v141, v125
    v_mfma_f32_32x32x16_bf16 v[74:89], v[194:197], v[154:157], v[74:89]
    v_exp_f32 v142, v126
    v_exp_f32 v143, v127
    v_exp_f32 v144, v128
    v_exp_f32 v145, v129
    v_mfma_f32_32x32x16_bf16 v[74:89], v[198:201], v[158:161], v[74:89]
    v_exp_f32 v146, v130
    v_exp_f32 v147, v131
    v_exp_f32 v148, v132
    v_exp_f32 v149, v133
    v_exp_f32 v150, v134
    v_exp_f32 v151, v135
    v_exp_f32 v152, v136
    v_exp_f32 v153, v137
    s_waitcnt lgkmcnt(0)
    buffer_load_dwordx4 v[202:203], s[44:47], 0 idxen offen offset:0 sc1 lds
    buffer_load_dwordx4 v[204:205], s[44:47], 0 idxen offen offset:1024 sc1 lds
    buffer_load_dwordx4 v[206:207], s[44:47], 0 idxen offen offset:2048 sc1 lds
    buffer_load_dwordx4 v[208:209], s[44:47], 0 idxen offen offset:3072 sc1 lds
    v_pk_add_f32 v[138:139], v[138:139], 1.0 op_sel_hi:[1,0]
    v_pk_add_f32 v[140:141], v[140:141], 1.0 op_sel_hi:[1,0]
    v_pk_add_f32 v[142:143], v[142:143], 1.0 op_sel_hi:[1,0]
    v_pk_add_f32 v[144:145], v[144:145], 1.0 op_sel_hi:[1,0]
    v_pk_add_f32 v[146:147], v[146:147], 1.0 op_sel_hi:[1,0]
    v_pk_add_f32 v[148:149], v[148:149], 1.0 op_sel_hi:[1,0]
    v_pk_add_f32 v[150:151], v[150:151], 1.0 op_sel_hi:[1,0]
    v_pk_add_f32 v[152:153], v[152:153], 1.0 op_sel_hi:[1,0]
    v_mfma_f32_32x32x16_bf16 v[106:121], v[162:165], v[2:5], v[106:121]
    v_rcp_f32 v138, v138
    v_rcp_f32 v139, v139
    v_rcp_f32 v140, v140
    v_rcp_f32 v141, v141
    v_mfma_f32_32x32x16_bf16 v[106:121], v[166:169], v[6:9], v[106:121]
    v_rcp_f32 v142, v142
    v_rcp_f32 v143, v143
    v_rcp_f32 v144, v144
    v_rcp_f32 v145, v145
    v_rcp_f32 v146, v146
    v_rcp_f32 v147, v147
    v_rcp_f32 v148, v148
    v_rcp_f32 v149, v149
    v_rcp_f32 v150, v150
    v_rcp_f32 v151, v151
    v_rcp_f32 v152, v152
    v_rcp_f32 v153, v153
    v_pk_mul_f32 v[138:139], v[122:123], v[138:139]
    s_lshl_b32 s67, s65, 3
    v_pk_mul_f32 v[140:141], v[124:125], v[140:141]
    s_mov_b32 s64, s65
    v_pk_mul_f32 v[142:143], v[126:127], v[142:143]
    s_mov_b32 s73, s72
    v_pk_mul_f32 v[144:145], v[128:129], v[144:145]
    s_mov_b32 s71, s70
    v_pk_mul_f32 v[146:147], v[130:131], v[146:147]
    s_mov_b32 s70, s69
    v_pk_mul_f32 v[148:149], v[132:133], v[148:149]
    s_mov_b32 s75, s74
    v_pk_mul_f32 v[150:151], v[134:135], v[150:151]
    s_sub_u32 s83, s66, s64
    v_pk_mul_f32 v[152:153], v[136:137], v[152:153]
    s_min_u32 s76, s83, 64
    v_cvt_pk_bf16_f32 v154, v138, v139
    s_bfm_b64 s[80:81], s83, 0
    v_cvt_pk_bf16_f32 v155, v140, v141
    s_cmp_ge_u32 s83, 64
    v_cvt_pk_bf16_f32 v156, v142, v143
    s_cselect_b64 s[80:81], -1, s[80:81]
    v_cvt_pk_bf16_f32 v157, v144, v145
    s_mov_b32 s72, 0
    v_cvt_pk_bf16_f32 v158, v146, v147
    s_cmp_lg_u32 s74, 0
    v_cvt_pk_bf16_f32 v159, v148, v149
    v_cvt_pk_bf16_f32 v160, v150, v151
    v_cvt_pk_bf16_f32 v161, v152, v153
    s_cbranch_scc1 K_loop
K_drain:
    s_nop 0
    v_mfma_f32_32x32x16_bf16 v[90:105], v[194:197], v[154:157], v[90:105]
    v_mfma_f32_32x32x16_bf16 v[90:105], v[198:201], v[158:161], v[90:105]
    ds_write_b64 v226, v[210:211]
    s_mul_i32 s89, s70, 33
    v_lshl_add_u32 v246, s70, 1, v241
    v_add_u32 v245, s89, v240
    v_mul_f32 v74, 3207688728, v74
    v_mul_f32 v78, 3207688728, v78
    v_mul_f32 v82, 3207688728, v82
    v_mul_f32 v86, 3207688728, v86
    v_mul_f32 v75, v75, v242
    v_mul_f32 v76, v76, v242
    v_mul_f32 v77, v77, v242
    v_mul_f32 v79, v79, v242
    v_mul_f32 v80, v80, v242
    v_mul_f32 v81, v81, v242
    v_mul_f32 v83, v83, v242
    v_mul_f32 v84, v84, v242
    v_mul_f32 v85, v85, v242
    v_mul_f32 v87, v87, v242
    v_mul_f32 v88, v88, v242
    v_mul_f32 v89, v89, v242
    v_cvt_f64_f32 v[138:139], v74
    v_cvt_f64_f32 v[142:143], v78
    v_cvt_f64_f32 v[146:147], v82
    v_cvt_f64_f32 v[150:151], v86
    v_mul_f32 v90, 3207688728, v90
    v_mul_f32 v94, 3207688728, v94
    v_mul_f32 v98, 3207688728, v98
    v_mul_f32 v102, 3207688728, v102
    v_cvt_f64_f32 v[140:141], v90
    v_cvt_f64_f32 v[144:145], v94
    v_cvt_f64_f32 v[148:149], v98
    v_cvt_f64_f32 v[152:153], v102
    ds_add_f64 v245, v[138:139] offset:0
    ds_add_f64 v245, v[140:141] offset:256
    ds_add_f64 v245, v[142:143] offset:1056
    ds_add_f64 v245, v[144:145] offset:1312
    ds_add_f64 v245, v[146:147] offset:2112
    ds_add_f64 v245, v[148:149] offset:2368
    ds_add_f64 v245, v[150:151] offset:3168
    ds_add_f64 v245, v[152:153] offset:3424
    v_fmac_f32 v75, v91, v243
    v_fmac_f32 v76, v92, v243
    v_fmac_f32 v77, v93, v243
    v_fmac_f32 v79, v95, v243
    v_fmac_f32 v80, v96, v243
    v_fmac_f32 v81, v97, v243
    v_fmac_f32 v83, v99, v243
    v_fmac_f32 v84, v100, v243
    v_fmac_f32 v85, v101, v243
    v_fmac_f32 v87, v103, v243
    v_fmac_f32 v88, v104, v243
    v_fmac_f32 v89, v105, v243
    v_mfma_f32_32x32x16_bf16 v[90:105], v[210:213], v[210:213], 0
    v_add_f32_dpp v75, v75, v75 row_ror:8 row_mask:0xf bank_mask:0x3
    v_add_f32_dpp v76, v76, v76 row_ror:8 row_mask:0xf bank_mask:0x3
    v_add_f32_dpp v77, v77, v77 row_ror:8 row_mask:0xf bank_mask:0x3
    v_add_f32_dpp v79, v79, v79 row_ror:8 row_mask:0xf bank_mask:0x3
    v_add_f32_dpp v80, v80, v80 row_ror:8 row_mask:0xf bank_mask:0x3
    v_add_f32_dpp v81, v81, v81 row_ror:8 row_mask:0xf bank_mask:0x3
    v_add_f32_dpp v75, v83, v83 row_ror:8 row_mask:0xf bank_mask:0xc
    v_add_f32_dpp v76, v84, v84 row_ror:8 row_mask:0xf bank_mask:0xc
    v_add_f32_dpp v77, v85, v85 row_ror:8 row_mask:0xf bank_mask:0xc
    v_add_f32_dpp v79, v87, v87 row_ror:8 row_mask:0xf bank_mask:0xc
    v_add_f32_dpp v80, v88, v88 row_ror:8 row_mask:0xf bank_mask:0xc
    v_add_f32_dpp v81, v89, v89 row_ror:8 row_mask:0xf bank_mask:0xc
    v_add_f32_dpp v75, v75, v75 row_half_mirror row_mask:0xf bank_mask:0x5
    v_add_f32_dpp v76, v76, v76 row_half_mirror row_mask:0xf bank_mask:0x5
    v_add_f32_dpp v77, v77, v77 row_half_mirror row_mask:0xf bank_mask:0x5
    v_add_f32_dpp v75, v79, v79 row_half_mirror row_mask:0xf bank_mask:0xa
    v_add_f32_dpp v76, v80, v80 row_half_mirror row_mask:0xf bank_mask:0xa
    v_add_f32_dpp v77, v81, v81 row_half_mirror row_mask:0xf bank_mask:0xa
    v_add_f32_dpp v75, v75, v75 quad_perm:[1,0,3,2] row_mask:0xf bank_mask:0xf
    v_add_f32_dpp v76, v76, v76 quad_perm:[1,0,3,2] row_mask:0xf bank_mask:0xf
    v_add_f32_dpp v77, v77, v77 quad_perm:[1,0,3,2] row_mask:0xf bank_mask:0xf
    v_add_f32_dpp v75, v75, v75 quad_perm:[2,3,0,1] row_mask:0xf bank_mask:0xf
    v_add_f32_dpp v76, v76, v76 quad_perm:[2,3,0,1] row_mask:0xf bank_mask:0xf
    v_add_f32_dpp v77, v77, v77 quad_perm:[2,3,0,1] row_mask:0xf bank_mask:0xf
    v_cvt_f64_f32 v[138:139], v75
    v_cvt_f64_f32 v[140:141], v76
    v_cvt_f64_f32 v[142:143], v77
    v_mfma_f32_32x32x16_bf16 v[74:89], v[210:213], v[210:213], 0
    s_mov_b64 exec, s[96:97]
    ds_add_f64 v246, v[138:139] offset:0
    ds_add_f64 v246, v[140:141] offset:8
    ds_add_f64 v246, v[142:143] offset:16
    s_mov_b64 exec, -1
K_wavedone:
    s_setprio 0
    s_waitcnt vmcnt(0) lgkmcnt(0)
    s_barrier
    ds_read_b32 v245, v210 offset:32416
    ds_read_b128 v[106:109], v26 offset:0
    ds_read_b128 v[110:113], v26 offset:16
    ds_read_b128 v[114:117], v26 offset:32
    ds_read_b128 v[118:121], v26 offset:48
    ds_read_b128 v[122:125], v26 offset:128
    ds_read_b128 v[126:129], v26 offset:144
    ds_read_b128 v[130:133], v26 offset:160
    ds_read_b128 v[134:137], v26 offset:176
    ds_read_b128 v[74:77], v26 offset:256
    ds_read_b128 v[78:81], v26 offset:272
    ds_read_b128 v[82:85], v26 offset:288
    ds_read_b128 v[86:89], v26 offset:304
    ds_read_b128 v[90:93], v26 offset:384
    ds_read_b128 v[94:97], v26 offset:400
    ds_read_b128 v[98:101], v26 offset:416
    ds_read_b128 v[102:105], v26 offset:432
    ds_read_b64 v[220:221], v28
    ds_read_b32 v222, v27 offset:29184
    s_waitcnt lgkmcnt(14)
    v_readfirstlane_b32 s89, v245
    v_cvt_f32_f64 v106, v[106:107]
    v_cvt_f32_f64 v107, v[108:109]
    s_cmp_lg_u32 s89, 0
    s_cbranch_scc1 K_more
    v_cvt_f32_f64 v110, v[110:111]
    v_cvt_f32_f64 v111, v[112:113]
    v_cvt_pk_bf16_f32 v162, v106, v107
    v_cvt_f32_f64 v114, v[114:115]
    v_cvt_f32_f64 v115, v[116:117]
    v_cvt_pk_bf16_f32 v163, v110, v111
    v_cvt_f32_f64 v118, v[118:119]
    v_cvt_f32_f64 v119, v[120:121]
    v_cvt_pk_bf16_f32 v164, v114, v115
    s_waitcnt lgkmcnt(10)
    v_cvt_f32_f64 v122, v[122:123]
    v_cvt_f32_f64 v123, v[124:125]
    v_cvt_pk_bf16_f32 v165, v118, v119
    v_cvt_f32_f64 v126, v[126:127]
    v_cvt_f32_f64 v127, v[128:129]
    v_cvt_pk_bf16_f32 v166, v122, v123
    v_mfma_f32_32x32x16_bf16 v[34:49], v[50:53], v[162:165], v[34:49]
    v_cvt_f32_f64 v130, v[130:131]
    v_cvt_f32_f64 v131, v[132:133]
    v_cvt_pk_bf16_f32 v167, v126, v127
    v_cvt_f32_f64 v134, v[134:135]
    v_cvt_f32_f64 v135, v[136:137]
    v_cvt_pk_bf16_f32 v168, v130, v131
    s_waitcnt lgkmcnt(6)
    v_cvt_f32_f64 v74, v[74:75]
    v_cvt_f32_f64 v75, v[76:77]
    v_cvt_pk_bf16_f32 v169, v134, v135
    v_cvt_f32_f64 v78, v[78:79]
    v_cvt_f32_f64 v79, v[80:81]
    v_cvt_pk_bf16_f32 v170, v74, v75
    v_mfma_f32_32x32x16_bf16 v[34:49], v[54:57], v[166:169], v[34:49]
    v_cvt_f32_f64 v82, v[82:83]
    v_cvt_f32_f64 v83, v[84:85]
    v_cvt_pk_bf16_f32 v171, v78, v79
    v_cvt_f32_f64 v86, v[86:87]
    v_cvt_f32_f64 v87, v[88:89]
    v_cvt_pk_bf16_f32 v172, v82, v83
    s_waitcnt lgkmcnt(2)
    v_cvt_f32_f64 v90, v[90:91]
    v_cvt_f32_f64 v91, v[92:93]
    v_cvt_pk_bf16_f32 v173, v86, v87
    v_cvt_f32_f64 v94, v[94:95]
    v_cvt_f32_f64 v95, v[96:97]
    v_cvt_pk_bf16_f32 v174, v90, v91
    v_mfma_f32_32x32x16_bf16 v[34:49], v[58:61], v[170:173], v[34:49]
    v_cvt_f32_f64 v98, v[98:99]
    v_cvt_f32_f64 v99, v[100:101]
    v_cvt_pk_bf16_f32 v175, v94, v95
    v_cvt_f32_f64 v102, v[102:103]
    v_cvt_f32_f64 v103, v[104:105]
    v_cvt_pk_bf16_f32 v176, v98, v99
    v_cvt_pk_bf16_f32 v177, v102, v103
    s_waitcnt lgkmcnt(0)
    v_cvt_f32_f64 v220, v[220:221]
    v_mfma_f32_32x32x16_bf16 v[34:49], v[62:65], v[174:177], v[34:49]
    v_add_f32 v220, v220, v222
    v_cvt_pk_bf16_f32 v220, v220, v220
    buffer_store_short v220, v29, s[56:59], 0 offen sc0 sc1 nt
    s_nop 7
    s_nop 1
    v_pk_mul_f32 v[138:139], v[34:35], s[92:93]
    v_pk_mul_f32 v[140:141], v[36:37], s[92:93]
    v_pk_mul_f32 v[142:143], v[38:39], s[92:93]
    v_pk_mul_f32 v[144:145], v[40:41], s[92:93]
    v_pk_mul_f32 v[146:147], v[42:43], s[92:93]
    v_pk_mul_f32 v[148:149], v[44:45], s[92:93]
    v_pk_mul_f32 v[150:151], v[46:47], s[92:93]
    v_pk_mul_f32 v[152:153], v[48:49], s[92:93]
    v_exp_f32 v138, v138
    v_exp_f32 v139, v139
    v_exp_f32 v140, v140
    v_exp_f32 v141, v141
    v_exp_f32 v142, v142
    v_exp_f32 v143, v143
    v_exp_f32 v144, v144
    v_exp_f32 v145, v145
    v_exp_f32 v146, v146
    v_exp_f32 v147, v147
    v_exp_f32 v148, v148
    v_exp_f32 v149, v149
    v_exp_f32 v150, v150
    v_exp_f32 v151, v151
    v_exp_f32 v152, v152
    v_exp_f32 v153, v153
    v_pk_add_f32 v[138:139], v[138:139], 1.0 op_sel_hi:[1,0]
    v_pk_add_f32 v[140:141], v[140:141], 1.0 op_sel_hi:[1,0]
    v_pk_add_f32 v[142:143], v[142:143], 1.0 op_sel_hi:[1,0]
    v_pk_add_f32 v[144:145], v[144:145], 1.0 op_sel_hi:[1,0]
    v_pk_add_f32 v[146:147], v[146:147], 1.0 op_sel_hi:[1,0]
    v_pk_add_f32 v[148:149], v[148:149], 1.0 op_sel_hi:[1,0]
    v_pk_add_f32 v[150:151], v[150:151], 1.0 op_sel_hi:[1,0]
    v_pk_add_f32 v[152:153], v[152:153], 1.0 op_sel_hi:[1,0]
    v_rcp_f32 v138, v138
    v_rcp_f32 v139, v139
    v_rcp_f32 v140, v140
    v_rcp_f32 v141, v141
    v_rcp_f32 v142, v142
    v_rcp_f32 v143, v143
    v_rcp_f32 v144, v144
    v_rcp_f32 v145, v145
    v_rcp_f32 v146, v146
    v_rcp_f32 v147, v147
    v_rcp_f32 v148, v148
    v_rcp_f32 v149, v149
    v_rcp_f32 v150, v150
    v_rcp_f32 v151, v151
    v_rcp_f32 v152, v152
    v_rcp_f32 v153, v153
    v_pk_fma_f32 v[138:139], v[34:35], v[138:139], v[10:11]
    v_pk_fma_f32 v[140:141], v[36:37], v[140:141], v[12:13]
    v_pk_fma_f32 v[142:143], v[38:39], v[142:143], v[14:15]
    v_pk_fma_f32 v[144:145], v[40:41], v[144:145], v[16:17]
    v_cvt_pk_bf16_f32 v162, v138, v139
    v_cvt_pk_bf16_f32 v163, v140, v141
    v_cvt_pk_bf16_f32 v164, v142, v143
    v_cvt_pk_bf16_f32 v165, v144, v145
    ds_write_b128 v30, v[162:165]
    v_pk_fma_f32 v[146:147], v[42:43], v[146:147], v[18:19]
    v_pk_fma_f32 v[148:149], v[44:45], v[148:149], v[20:21]
    v_pk_fma_f32 v[150:151], v[46:47], v[150:151], v[22:23]
    v_pk_fma_f32 v[152:153], v[48:49], v[152:153], v[24:25]
    v_cvt_pk_bf16_f32 v166, v146, v147
    v_cvt_pk_bf16_f32 v167, v148, v149
    v_cvt_pk_bf16_f32 v168, v150, v151
    v_cvt_pk_bf16_f32 v169, v152, v153
    ds_write_b128 v31, v[166:169]
    ds_read_b128 v[170:173], v32
    ds_read_b128 v[174:177], v32 offset:1024
    s_waitcnt lgkmcnt(1)
    buffer_store_dwordx4 v[170:173], v252, s[52:55], 0 offen sc0 sc1 nt
    s_waitcnt lgkmcnt(0)
    buffer_store_dwordx4 v[174:177], v254, s[52:55], 0 offen offset:2048 sc0 sc1 nt
K_fin:
K_end:
    s_endpgm
K_flush:
    s_mul_i32 s89, s71, 33
    v_lshl_add_u32 v246, s71, 1, v241
    v_add_u32 v245, s89, v240
    v_mul_f32 v74, 3207688728, v74
    v_mul_f32 v78, 3207688728, v78
    v_mul_f32 v82, 3207688728, v82
    v_mul_f32 v86, 3207688728, v86
    v_mul_f32 v75, v75, v242
    v_mul_f32 v76, v76, v242
    v_mul_f32 v77, v77, v242
    v_mul_f32 v79, v79, v242
    v_mul_f32 v80, v80, v242
    v_mul_f32 v81, v81, v242
    v_mul_f32 v83, v83, v242
    v_mul_f32 v84, v84, v242
    v_mul_f32 v85, v85, v242
    v_mul_f32 v87, v87, v242
    v_mul_f32 v88, v88, v242
    v_mul_f32 v89, v89, v242
    v_cvt_f64_f32 v[138:139], v74
    v_cvt_f64_f32 v[142:143], v78
    v_cvt_f64_f32 v[146:147], v82
    v_cvt_f64_f32 v[150:151], v86
    v_mul_f32 v90, 3207688728, v90
    v_mul_f32 v94, 3207688728, v94
    v_mul_f32 v98, 3207688728, v98
    v_mul_f32 v102, 3207688728, v102
    v_cvt_f64_f32 v[140:141], v90
    v_cvt_f64_f32 v[144:145], v94
    v_cvt_f64_f32 v[148:149], v98
    v_cvt_f64_f32 v[152:153], v102
    ds_add_f64 v245, v[138:139] offset:0
    ds_add_f64 v245, v[140:141] offset:256
    ds_add_f64 v245, v[142:143] offset:1056
    ds_add_f64 v245, v[144:145] offset:1312
    ds_add_f64 v245, v[146:147] offset:2112
    ds_add_f64 v245, v[148:149] offset:2368
    ds_add_f64 v245, v[150:151] offset:3168
    ds_add_f64 v245, v[152:153] offset:3424
    v_fmac_f32 v75, v91, v243
    v_fmac_f32 v76, v92, v243
    v_fmac_f32 v77, v93, v243
    v_fmac_f32 v79, v95, v243
    v_fmac_f32 v80, v96, v243
    v_fmac_f32 v81, v97, v243
    v_fmac_f32 v83, v99, v243
    v_fmac_f32 v84, v100, v243
    v_fmac_f32 v85, v101, v243
    v_fmac_f32 v87, v103, v243
    v_fmac_f32 v88, v104, v243
    v_fmac_f32 v89, v105, v243
    v_mfma_f32_32x32x16_bf16 v[90:105], v[210:213], v[210:213], 0
    v_add_f32_dpp v75, v75, v75 row_ror:8 row_mask:0xf bank_mask:0x3
    v_add_f32_dpp v76, v76, v76 row_ror:8 row_mask:0xf bank_mask:0x3
    v_add_f32_dpp v77, v77, v77 row_ror:8 row_mask:0xf bank_mask:0x3
    v_add_f32_dpp v79, v79, v79 row_ror:8 row_mask:0xf bank_mask:0x3
    v_add_f32_dpp v80, v80, v80 row_ror:8 row_mask:0xf bank_mask:0x3
    v_add_f32_dpp v81, v81, v81 row_ror:8 row_mask:0xf bank_mask:0x3
    v_add_f32_dpp v75, v83, v83 row_ror:8 row_mask:0xf bank_mask:0xc
    v_add_f32_dpp v76, v84, v84 row_ror:8 row_mask:0xf bank_mask:0xc
    v_add_f32_dpp v77, v85, v85 row_ror:8 row_mask:0xf bank_mask:0xc
    v_add_f32_dpp v79, v87, v87 row_ror:8 row_mask:0xf bank_mask:0xc
    v_add_f32_dpp v80, v88, v88 row_ror:8 row_mask:0xf bank_mask:0xc
    v_add_f32_dpp v81, v89, v89 row_ror:8 row_mask:0xf bank_mask:0xc
    v_add_f32_dpp v75, v75, v75 row_half_mirror row_mask:0xf bank_mask:0x5
    v_add_f32_dpp v76, v76, v76 row_half_mirror row_mask:0xf bank_mask:0x5
    v_add_f32_dpp v77, v77, v77 row_half_mirror row_mask:0xf bank_mask:0x5
    v_add_f32_dpp v75, v79, v79 row_half_mirror row_mask:0xf bank_mask:0xa
    v_add_f32_dpp v76, v80, v80 row_half_mirror row_mask:0xf bank_mask:0xa
    v_add_f32_dpp v77, v81, v81 row_half_mirror row_mask:0xf bank_mask:0xa
    v_add_f32_dpp v75, v75, v75 quad_perm:[1,0,3,2] row_mask:0xf bank_mask:0xf
    v_add_f32_dpp v76, v76, v76 quad_perm:[1,0,3,2] row_mask:0xf bank_mask:0xf
    v_add_f32_dpp v77, v77, v77 quad_perm:[1,0,3,2] row_mask:0xf bank_mask:0xf
    v_add_f32_dpp v75, v75, v75 quad_perm:[2,3,0,1] row_mask:0xf bank_mask:0xf
    v_add_f32_dpp v76, v76, v76 quad_perm:[2,3,0,1] row_mask:0xf bank_mask:0xf
    v_add_f32_dpp v77, v77, v77 quad_perm:[2,3,0,1] row_mask:0xf bank_mask:0xf
    v_cvt_f64_f32 v[138:139], v75
    v_cvt_f64_f32 v[140:141], v76
    v_cvt_f64_f32 v[142:143], v77
    v_mfma_f32_32x32x16_bf16 v[74:89], v[210:213], v[210:213], 0
    s_mov_b64 exec, s[96:97]
    ds_add_f64 v246, v[138:139] offset:0
    ds_add_f64 v246, v[140:141] offset:8
    ds_add_f64 v246, v[142:143] offset:16
    s_mov_b64 exec, -1
    s_branch K_flushb
K_win_1a:
    v_readfirstlane_b32 s69, v215
    s_mov_b32 s72, 1
    s_add_u32 s68, s69, 128
    v_cmp_gt_u32 vcc, s68, v215
    s_nop 0
    s_and_b64 s[78:79], vcc, s[80:81]
    s_bcnt1_i32_b64 s74, s[78:79]
    s_branch K_win_1b
K_win_2a:
    v_readfirstlane_b32 s69, v215
    s_mov_b32 s72, 1
    s_add_u32 s68, s69, 128
    v_cmp_gt_u32 vcc, s68, v215
    s_nop 0
    s_and_b64 s[78:79], vcc, s[80:81]
    s_bcnt1_i32_b64 s74, s[78:79]
    s_branch K_win_2b
K_prioa:
    s_setprio 2
    s_cmp_le_u32 s83, 64
    s_cbranch_scc0 K_prioba
    s_setprio 1
    s_cmp_le_u32 s83, 0
    s_cbranch_scc0 K_prioba
    s_setprio 0
    s_branch K_prioba
K_aw:
    s_mul_i32 s89, s69, 9
    s_mov_b64 exec, s[94:95]
    v_add_u32 v238, s89, v239
    s_mov_b64 exec, -1
    ds_read_b64_tr_b16 v[178:179], v238 offset:0
    ds_read_b64_tr_b16 v[180:181], v238 offset:576
    ds_read_b64_tr_b16 v[182:183], v238 offset:64
    ds_read_b64_tr_b16 v[184:185], v238 offset:640
    s_branch K_awb
K_reflg:
    s_add_u32 s63, s63, 1
    s_cmp_gt_u32 s63, 0x40000
    s_cbranch_scc1 K_flgok
    buffer_load_dwordx2 v[216:217], v245, s[40:43], s62 offen sc1
    s_branch K_flg
K_repoll:
    s_mov_b64 exec, s[4:5]
    buffer_load_dwordx2 v[162:163], v176, s[40:43], s16 offen sc1
    s_mov_b64 exec, s[6:7]
    buffer_load_dwordx2 v[164:165], v176, s[40:43], s17 offen sc1
    s_mov_b64 exec, -1
    s_branch K_poll
K_ovla:
    s_mov_b32 s76, 1
    v_and_b32 v176, 3, v1
    v_lshlrev_b32 v177, 2, v176
    v_subrev_u32 v177, 24, v177
    v_add_u32 v138, v134, v177
    v_sub_u32 v130, v130, v177
    v_lshlrev_b32 v176, 2, v177
    v_cmp_lt_i32 s[28:29], 0, v138
    v_sub_u32 v128, v128, v176
    v_cmp_lt_i32 s[30:31], 1, v138
    s_mov_b64 exec, s[28:29]
    buffer_load_ushort v126, v130, s[40:43], s36 offen sc1
    buffer_load_dwordx2 v[118:119], v128, s[40:43], s36 offen sc1
    s_mov_b64 exec, -1
    v_add_u32 v139, v135, v177
    v_sub_u32 v131, v131, v177
    v_lshlrev_b32 v176, 2, v177
    v_cmp_lt_i32 s[32:33], 0, v139
    v_sub_u32 v129, v129, v176
    v_cmp_lt_i32 s[34:35], 1, v139
    s_mov_b64 exec, s[32:33]
    buffer_load_ushort v127, v131, s[40:43], s37 offen sc1
    buffer_load_dwordx2 v[120:121], v129, s[40:43], s37 offen sc1
    s_mov_b64 exec, -1
    s_branch K_ovlba
K_ovh:
    s_waitcnt vmcnt(0)
    v_lshlrev_b32_sdwa v150, 2, v126 dst_sel:DWORD dst_unused:UNUSED_PAD src0_sel:DWORD src1_sel:BYTE_0
    v_lshlrev_b32_sdwa v151, 2, v126 dst_sel:DWORD dst_unused:UNUSED_PAD src0_sel:DWORD src1_sel:BYTE_1
    v_lshlrev_b32_sdwa v152, 2, v127 dst_sel:DWORD dst_unused:UNUSED_PAD src0_sel:DWORD src1_sel:BYTE_0
    v_lshlrev_b32_sdwa v153, 2, v127 dst_sel:DWORD dst_unused:UNUSED_PAD src0_sel:DWORD src1_sel:BYTE_1
    s_mov_b64 exec, s[28:29]
    ds_add_rtn_u32 v166, v150, v176 offset:31392
    s_mov_b64 exec, s[30:31]
    ds_add_rtn_u32 v167, v151, v176 offset:31392
    s_mov_b64 exec, s[32:33]
    ds_add_rtn_u32 v168, v152, v176 offset:31392
    s_mov_b64 exec, s[34:35]
    ds_add_rtn_u32 v169, v153, v176 offset:31392
    s_mov_b64 exec, -1
    s_branch K_ovhb
K_ovs:
    s_mov_b64 exec, s[28:29]
    ds_read_b32 v150, v150 offset:31904
    s_mov_b64 exec, s[30:31]
    ds_read_b32 v151, v151 offset:31904
    s_mov_b64 exec, s[32:33]
    ds_read_b32 v152, v152 offset:31904
    s_mov_b64 exec, s[34:35]
    ds_read_b32 v153, v153 offset:31904
    s_mov_b64 exec, -1
    s_waitcnt lgkmcnt(0)
    v_add_lshl_u32 v150, v150, v166, 3
    v_add_lshl_u32 v151, v151, v167, 3
    v_add_lshl_u32 v152, v152, v168, 3
    v_add_lshl_u32 v153, v153, v169, 3
    v_lshlrev_b32_sdwa v166, 4, v126 dst_sel:DWORD dst_unused:UNUSED_PAD src0_sel:DWORD src1_sel:BYTE_0
    v_lshlrev_b32_sdwa v167, 4, v126 dst_sel:DWORD dst_unused:UNUSED_PAD src0_sel:DWORD src1_sel:BYTE_1
    v_lshlrev_b32_sdwa v168, 4, v127 dst_sel:DWORD dst_unused:UNUSED_PAD src0_sel:DWORD src1_sel:BYTE_0
    v_lshlrev_b32_sdwa v169, 4, v127 dst_sel:DWORD dst_unused:UNUSED_PAD src0_sel:DWORD src1_sel:BYTE_1
    s_mov_b64 exec, s[28:29]
    ds_write2_b32 v150, v118, v166 offset0:0 offset1:1
    s_mov_b64 exec, s[30:31]
    ds_write2_b32 v151, v119, v167 offset0:0 offset1:1
    s_mov_b64 exec, s[32:33]
    ds_write2_b32 v152, v120, v168 offset0:0 offset1:1
    s_mov_b64 exec, s[34:35]
    ds_write2_b32 v153, v121, v169 offset0:0 offset1:1
    s_mov_b64 exec, -1
    s_branch K_ovsb
K_setflag:
    v_mov_b32 v176, 1
    v_mov_b32 v177, 32416
    ds_write_b32 v177, v176
    s_waitcnt lgkmcnt(0)
    s_branch K_flagset
K_skip:
    s_cmp_lg_u32 s98, 0
    s_cbranch_scc1 K_wavedone
    v_and_b32 v141, 31, v1
    v_lshrrev_b32 v142, 5, v1
    v_bfe_u32 v143, v1, 1, 3
    v_and_b32 v144, 3, v1
    s_lshl_b32 s89, s86, 5
    v_add_u32 v138, s89, v141
    v_mul_u32_u24 v26, 528, v138
    v_lshl_add_u32 v26, v142, 6, v26
    v_add_u32 v26, 50048, v26
    v_lshlrev_b32 v27, 2, v0
    v_lshlrev_b32 v28, 3, v0
    v_add_u32 v28, 105488, v28
    v_lshrrev_b32 v29, 2, v0
    v_cmp_gt_u32 vcc, 98, v29
    v_cmp_gt_u32 s[36:37], 3, v144
    v_add_u32 v29, s85, v29
    v_mul_u32_u24 v29, 6, v29
    v_lshl_add_u32 v29, v144, 1, v29
    s_and_b64 vcc, s[36:37], vcc
    v_mov_b32 v140, 0x1000000
    v_and_b32 v138, 3, v143
    v_cndmask_b32 v29, v140, v29, vcc
    v_lshlrev_b32 v139, 1, v142
    v_xor_b32 v139, v139, v138
    v_lshl_add_u32 v30, v141, 6, s88
    v_lshl_add_u32 v30, v139, 4, v30
    v_xor_b32 v31, 16, v30
    v_lshl_add_u32 v32, v1, 4, s88
    v_lshlrev_b32 v10, 16, v66
    v_and_b32 v11, 0xffff0000, v66
    v_lshlrev_b32 v12, 16, v67
    v_and_b32 v13, 0xffff0000, v67
    v_lshlrev_b32 v14, 16, v68
    v_and_b32 v15, 0xffff0000, v68
    v_lshlrev_b32 v16, 16, v69
    v_and_b32 v17, 0xffff0000, v69
    v_lshlrev_b32 v18, 16, v70
    v_and_b32 v19, 0xffff0000, v70
    v_lshlrev_b32 v20, 16, v71
    v_and_b32 v21, 0xffff0000, v71
    v_lshlrev_b32 v22, 16, v72
    v_and_b32 v23, 0xffff0000, v72
    v_lshlrev_b32 v24, 16, v73
    v_and_b32 v25, 0xffff0000, v73
    s_branch K_wavedone
K_retry:
    s_waitcnt lgkmcnt(0)
    s_barrier
    v_cmp_gt_u32 vcc, 65, v0
    v_lshlrev_b32 v176, 4, v0
    s_nop 0
    s_mov_b64 exec, vcc
    ds_write_b128 v176, v[210:213] offset:31392
    s_mov_b64 exec, -1
    s_waitcnt lgkmcnt(0)
    s_barrier
    s_mov_b32 s99, 8
    s_mov_b32 s76, 0
    s_add_u32 s89, s98, 8
    v_min_u32 v177, s89, v132
    v_sub_u32 v177, v177, v175
    v_cmp_lt_i32 s[4:5], 0, v177
    v_cmp_lt_i32 s[6:7], 1, v177
    v_cmp_lt_i32 s[8:9], 2, v177
    v_cmp_lt_i32 s[10:11], 3, v177
    v_cmp_lt_i32 s[12:13], 4, v177
    v_cmp_lt_i32 s[14:15], 5, v177
    v_min_u32 v177, s89, v133
    v_sub_u32 v177, v177, v175
    v_cmp_lt_i32 s[16:17], 0, v177
    v_cmp_lt_i32 s[18:19], 1, v177
    v_cmp_lt_i32 s[20:21], 2, v177
    v_cmp_lt_i32 s[22:23], 3, v177
    v_cmp_lt_i32 s[24:25], 4, v177
    v_cmp_lt_i32 s[26:27], 5, v177
    s_branch K_hist
K_more:
    s_waitcnt lgkmcnt(0)
    s_barrier
    v_cmp_gt_u32 vcc, 65, v0
    v_lshlrev_b32 v176, 4, v0
    s_nop 0
    s_mov_b64 exec, vcc
    ds_write_b128 v176, v[210:213] offset:31392
    s_mov_b64 exec, -1
    s_waitcnt lgkmcnt(0)
    s_barrier
    v_mfma_f32_32x32x16_bf16 v[74:89], v[210:213], v[210:213], 0
    v_mfma_f32_32x32x16_bf16 v[90:105], v[210:213], v[210:213], 0
    v_mov_b32 v186, 0
    v_mov_b32 v187, 0
    v_mov_b32 v188, 0
    v_mov_b32 v189, 0
    v_mov_b32 v190, 0
    v_mov_b32 v191, 0
    v_mov_b32 v192, 0
    v_mov_b32 v193, 0
    v_mov_b32 v194, 0
    v_mov_b32 v195, 0
    v_mov_b32 v196, 0
    v_mov_b32 v197, 0
    v_mov_b32 v198, 0
    v_mov_b32 v199, 0
    v_mov_b32 v200, 0
    v_mov_b32 v201, 0
    s_add_u32 s98, s98, s99
    s_mov_b32 s99, 32
    v_lshrrev_b32 v176, 2, v1
    v_lshlrev_b32 v176, 11, v176
    s_lshl_b32 s89, s3, 16
    s_lshl_b32 s90, s84, 3
    s_add_u32 s89, s89, s90
    s_add_u32 s16, s89, 6422528
    s_add_u32 s17, s16, 32768
    buffer_load_dwordx2 v[162:163], v176, s[40:43], s16 offen sc1
    buffer_load_dwordx2 v[164:165], v176, s[40:43], s17 offen sc1
    s_mov_b32 s89, 15744
    v_lshrrev_b32 v174, 2, v1
    v_and_b32 v175, 3, v1
    v_mul_u32_u24 v174, s89, v174
    v_mad_u32_u24 v175, v175, 6, s98
    s_mul_i32 s36, s3, 503808
    s_add_u32 s37, s36, 251904
    v_add_u32 v173, v174, v175
    v_add_u32 v173, 12544, v173
    v_lshl_add_u32 v174, v175, 2, v174
    s_add_u32 s38, s98, 24
    s_waitcnt vmcnt(0)
    v_bfe_u32 v132, v162, 12, 12
    v_and_b32 v176, 0xfff, v162
    v_sub_u32 v134, v132, v175
    v_add_u32 v130, v176, v173
    v_cmp_lt_i32 s[4:5], 0, v134
    v_lshl_add_u32 v128, v176, 2, v174
    v_cmp_lt_i32 s[12:13], 4, v134
    s_mov_b64 exec, s[4:5]
    buffer_load_dwordx2 v[122:123], v130, s[40:43], s36 offen sc1
    s_mov_b64 exec, -1
    v_bfe_u32 v133, v164, 12, 12
    v_and_b32 v176, 0xfff, v164
    v_sub_u32 v135, v133, v175
    v_add_u32 v131, v176, v173
    v_cmp_lt_i32 s[16:17], 0, v135
    v_lshl_add_u32 v129, v176, 2, v174
    v_cmp_lt_i32 s[24:25], 4, v135
    s_mov_b64 exec, s[16:17]
    buffer_load_dwordx2 v[124:125], v131, s[40:43], s37 offen sc1
    s_mov_b64 exec, -1
    v_max_u32 v244, v132, v133
    s_mov_b64 exec, s[4:5]
    buffer_load_dwordx4 v[106:109], v128, s[40:43], s36 offen sc1
    s_mov_b64 exec, s[12:13]
    buffer_load_dwordx2 v[110:111], v128, s[40:43], s36 offen offset:16 sc1
    s_mov_b64 exec, s[16:17]
    buffer_load_dwordx4 v[112:115], v129, s[40:43], s37 offen sc1
    s_mov_b64 exec, s[24:25]
    buffer_load_dwordx2 v[116:117], v129, s[40:43], s37 offen offset:16 sc1
    s_mov_b64 exec, -1
    v_cmp_lt_u32 vcc, s38, v244
    s_mov_b32 s76, 0
    v_cmp_lt_i32 s[6:7], 1, v134
    v_cmp_lt_i32 s[8:9], 2, v134
    v_cmp_lt_i32 s[10:11], 3, v134
    v_cmp_lt_i32 s[14:15], 5, v134
    v_cmp_lt_i32 s[18:19], 1, v135
    v_cmp_lt_i32 s[20:21], 2, v135
    v_cmp_lt_i32 s[22:23], 3, v135
    v_cmp_lt_i32 s[26:27], 5, v135
    s_cbranch_vccnz K_ovlb
K_ovlbb:
    s_branch K_hist
K_ovlb:
    s_mov_b32 s76, 1
    v_and_b32 v176, 3, v1
    v_lshlrev_b32 v177, 2, v176
    v_subrev_u32 v177, 24, v177
    v_add_u32 v138, v134, v177
    v_sub_u32 v130, v130, v177
    v_lshlrev_b32 v176, 2, v177
    v_cmp_lt_i32 s[28:29], 0, v138
    v_sub_u32 v128, v128, v176
    v_cmp_lt_i32 s[30:31], 1, v138
    s_mov_b64 exec, s[28:29]
    buffer_load_ushort v126, v130, s[40:43], s36 offen sc1
    buffer_load_dwordx2 v[118:119], v128, s[40:43], s36 offen sc1
    s_mov_b64 exec, -1
    v_add_u32 v139, v135, v177
    v_sub_u32 v131, v131, v177
    v_lshlrev_b32 v176, 2, v177
    v_cmp_lt_i32 s[32:33], 0, v139
    v_sub_u32 v129, v129, v176
    v_cmp_lt_i32 s[34:35], 1, v139
    s_mov_b64 exec, s[32:33]
    buffer_load_ushort v127, v131, s[40:43], s37 offen sc1
    buffer_load_dwordx2 v[120:121], v129, s[40:43], s37 offen sc1
    s_mov_b64 exec, -1
    s_branch K_ovlbb

.section .rodata,"a"
.p2align 6
.amdhsa_kernel standalone__cheap_equivariant_egnn__graph_kernel
  .amdhsa_next_free_vgpr 256
  .amdhsa_next_free_sgpr 102
  .amdhsa_accum_offset 256
  .amdhsa_group_segment_fixed_size 0
  .amdhsa_kernarg_size 88
  .amdhsa_user_sgpr_count 2
  .amdhsa_user_sgpr_kernarg_segment_ptr 1
  .amdhsa_system_sgpr_workgroup_id_x 1
  .amdhsa_float_denorm_mode_32 3
.end_amdhsa_kernel
```
